```python
import torch

def _softmax(x, axis=-1):
    return torch.softmax(x, dim=axis)
def _gelu(x):
    return torch.nn.functional.gelu(x, approximate="tanh")
def _silu(x):
    return torch.nn.functional.silu(x)
def _sigmoid(x):
    return torch.sigmoid(x)
def _layernorm(x, axis=-1, eps=1e-5):
    m = x.mean(dim=axis, keepdim=True)
    v = x.var(dim=axis, keepdim=True, unbiased=False)
    return (x - m) / torch.sqrt(v + eps)
def _scatter_add(tgt, idx, src, axis=0):
    return tgt.clone().index_add_(axis, idx, src)
def _segment_sum(src, seg, n):
    out = torch.zeros((n,) + src.shape[1:], dtype=src.dtype)
    return out.index_add_(0, seg, src)
def _pad(x, pw):
    flat = tuple(v for pair in reversed(pw) for v in pair)
    return torch.nn.functional.pad(x, flat)

kernel_name = 'parallel_sum__gqa_block_cached__mixer_token_mlp__decode'

def setup_inputs():

    _w = (lambda a: (lambda t: t.to(torch.bfloat16) if t.is_floating_point() else t)(torch.as_tensor(a)))
    def _A_setup():
        B, Sq, D = 1, 1, 512
        Hq, Hkv, Sk, Dh = 32, 8, 32768, 128
        assert Hq % Hkv == 0, (Hq, Hkv)
        return {
            "x": _w((lambda *s: torch.randn(*s, dtype=torch.bfloat16) * 0.05)(B, Sq, D)),
            "k_cache": _w((lambda *s: torch.randn(*s, dtype=torch.bfloat16) * 3.2)(B, Hkv, Sk, Dh)),
            "v_cache": _w((lambda *s: torch.randn(*s, dtype=torch.bfloat16) * 1.6)(B, Hkv, Sk, Dh)),
            "wq": _w((lambda *s: torch.randn(*s, dtype=torch.bfloat16) * 3.2)(D, Hq * Dh) * (D ** -0.5)),
            "wo": _w((lambda *s: torch.randn(*s, dtype=torch.bfloat16) * 1.6)(Hq * Dh, D) * ((Hq * Dh) ** -0.5)),
        }
    _A_in = _A_setup()

    def _B_setup():
        B, S, D, F = 1, 1, 512, 1792
        return {
            "x": _w((lambda *s: torch.randn(*s, dtype=torch.bfloat16) * 0.05)(B, S, D)),
            "w1": _w((lambda *s: torch.randn(*s, dtype=torch.bfloat16) * 1.6)(S, F) * (S ** -0.5)),
            "b1": _w((lambda *s: torch.randn(*s, dtype=torch.bfloat16) * 1.6)(F) * 0.02),
            "w2": _w((lambda *s: torch.randn(*s, dtype=torch.bfloat16) * 1.6)(F, S) * (F ** -0.5)),
            "b2": _w((lambda *s: torch.randn(*s, dtype=torch.bfloat16) * 1.6)(S) * 0.02),
        }
    _B_in = _B_setup()

    return {
        "A_x": _A_in["x"],
        "A_k_cache": _A_in["k_cache"],
        "A_v_cache": _A_in["v_cache"],
        "A_wq": _A_in["wq"],
        "A_wo": _A_in["wo"],
        "B_x": _B_in["x"],
        "B_w1": _B_in["w1"],
        "B_b1": _B_in["b1"],
        "B_w2": _B_in["w2"],
        "B_b2": _B_in["b2"],
    }

def reference(A_x, A_k_cache, A_v_cache, A_wq, A_wo, B_x, B_w1, B_b1, B_w2, B_b2):
    def _A_ref(x, k_cache, v_cache, wq, wo):
        B, Sq, D = x.shape
        Hq, Dh = 32, 128
        Hkv = k_cache.shape[1]
        rep = Hq // Hkv
        q = (lambda x, *d: x.permute(*d))((x @ wq).reshape(B, Sq, Hq, Dh), 0, 2, 1, 3)
        k = (lambda x, n, axis: torch.repeat_interleave(x, n, dim=axis))(k_cache, rep, axis=1)
        v = (lambda x, n, axis: torch.repeat_interleave(x, n, dim=axis))(v_cache, rep, axis=1)
        scores = torch.einsum("bhqd,bhkd->bhqk", q, k) * (Dh ** -0.5)
        p = _softmax(scores, axis=-1)
        o = torch.einsum("bhqk,bhkd->bhqd", p, v)
        return (lambda x, *d: x.permute(*d))(o, 0, 2, 1, 3).reshape(B, Sq, Hq * Dh) @ wo

    def _B_ref(x, w1, b1, w2, b2):
        B, S, D = x.shape
        h = _layernorm(x, axis=-1)
        u = torch.einsum("bsd,sf->bdf", h, w1) + b1
        u = _gelu(u)
        y = torch.einsum("bdf,fs->bds", u, w2) + b2
        return (lambda x, *d: x.permute(*d))(y, 0, 2, 1)

    x = A_x
    xn = _layernorm(x, axis=-1)
    return x + _A_ref(xn, A_k_cache, A_v_cache, A_wq, A_wo) + _B_ref(xn, B_w1, B_b1, B_w2, B_b2)
```

```asm
; @launch grid=(256,1,1) block=(384,1,1) lds=148992
.amdgcn_target "amdgcn-amd-amdhsa--gfx950"
.text
.globl parallel_sum__gqa_block_cached__mixer_token_mlp__decode_kernel
.p2align 8
.type parallel_sum__gqa_block_cached__mixer_token_mlp__decode_kernel,@function
parallel_sum__gqa_block_cached__mixer_token_mlp__decode_kernel:
    s_cmp_ge_u32 s2, 256
    s_cbranch_scc1 L_end
    s_load_dwordx16 s[16:31], s[0:1], 0
    s_load_dwordx8 s[32:39], s[0:1], 64
    s_load_dwordx2 s[40:41], s[0:1], 96
    s_memrealtime s[70:71]
    v_readfirstlane_b32 s3, v0
    v_and_b32 v0, 63, v0
    s_and_b32 s4, s2, 7
    s_lshr_b32 s5, s2, 3
    s_mov_b32 s6, 0xffff0000
    s_lshr_b32 s3, s3, 6
    s_cmp_eq_u32 s3, 4
    s_cbranch_scc1 L_ctrl
    s_cmp_gt_u32 s3, 4
    s_cbranch_scc1 L_bwave
    s_setprio 2
    v_lshrrev_b32 v20, 4, v0
    v_and_b32 v21, 15, v0
    v_xor_b32 v22, v20, v21
    v_lshlrev_b32 v22, 4, v22
    v_lshl_add_u32 v2, v20, 8, v22
    v_xor_b32 v3, 64, v2
    v_xor_b32 v4, 128, v2
    v_xor_b32 v5, 192, v2
    v_lshlrev_b32 v23, 2, v20
    v_xor_b32 v23, v23, v21
    v_lshlrev_b32 v23, 4, v23
    v_lshl_add_u32 v6, v20, 8, v23
    s_lshl_b32 s7, s4, 23
    s_lshl_b32 s8, s5, 18
    s_add_u32 s7, s7, s8
    s_lshl_b32 s8, s3, 12
    s_add_u32 s7, s7, s8
    s_mul_i32 s9, s3, 36864
    s_mov_b32 s46, 0x4000000
    s_mov_b32 s47, 0x00020000
    s_mov_b32 s50, 0x4000000
    s_mov_b32 s51, 0x00020000
    s_waitcnt lgkmcnt(0)
    s_mov_b32 s44, s18
    s_mov_b32 s45, s19
    s_mov_b32 s48, s20
    s_mov_b32 s49, s21
    s_xor_b32 s10, s7, 0
    s_add_u32 m0, s9, 0
    s_nop 0
    buffer_load_dwordx4 v2, s[44:47], s10 offen offset:0 nt lds
    buffer_load_dwordx4 v3, s[44:47], s10 offen offset:1024 nt lds
    buffer_load_dwordx4 v4, s[44:47], s10 offen offset:2048 nt lds
    buffer_load_dwordx4 v5, s[44:47], s10 offen offset:3072 nt lds
    s_xor_b32 s10, s7, 16384
    s_add_u32 m0, s9, 4096
    s_nop 0
    buffer_load_dwordx4 v2, s[44:47], s10 offen offset:0 nt lds
    buffer_load_dwordx4 v3, s[44:47], s10 offen offset:1024 nt lds
    buffer_load_dwordx4 v4, s[44:47], s10 offen offset:2048 nt lds
    buffer_load_dwordx4 v5, s[44:47], s10 offen offset:3072 nt lds
    s_xor_b32 s10, s7, 32768
    s_add_u32 m0, s9, 8192
    s_nop 0
    buffer_load_dwordx4 v2, s[44:47], s10 offen offset:0 nt lds
    buffer_load_dwordx4 v3, s[44:47], s10 offen offset:1024 nt lds
    v_lshl_add_u32 v8, v21, 8, v22
    v_add_u32 v8, s9, v8
    v_xor_b32 v9, 64, v8
    v_xor_b32 v10, 128, v8
    v_xor_b32 v11, 192, v8
    v_lshrrev_b32 v23, 2, v21
    v_bfe_u32 v24, v0, 1, 1
    v_lshl_add_u32 v24, v20, 1, v24
    v_lshlrev_b32 v25, 2, v23
    v_xor_b32 v24, v24, v25
    v_lshlrev_b32 v24, 4, v24
    v_lshl_add_u32 v24, v23, 8, v24
    v_and_b32 v25, 1, v0
    v_lshl_add_u32 v24, v25, 3, v24
    v_add_u32 v12, s9, v24
    v_xor_b32 v13, 128, v12
    v_and_b32 v24, 3, v0
    v_lshlrev_b32 v24, 8, v24
    v_lshl_add_u32 v24, v20, 4, v24
    v_add_u32 v24, 147456, v24
    v_lshlrev_b32 v25, 4, v20
    v_add_u32 v25, 148480, v25
    v_cmp_eq_u32 vcc, 0, v23
    s_nop 1
    v_cndmask_b32 v14, v25, v24, vcc
    v_cmp_eq_u32 vcc, 1, v23
    s_nop 1
    v_cndmask_b32 v15, v25, v24, vcc
    v_cmp_eq_u32 vcc, 2, v23
    s_nop 1
    v_cndmask_b32 v16, v25, v24, vcc
    v_cmp_eq_u32 vcc, 3, v23
    s_nop 1
    v_cndmask_b32 v17, v25, v24, vcc
    v_lshlrev_b32 v26, 4, v0
    v_add_u32 v26, s9, v26
    v_lshlrev_b32 v27, 3, v0
    s_lshl_b32 s8, s3, 5
    s_add_u32 s8, s8, 148736
    v_add_u32 v27, s8, v27
    s_mov_b32 s11, 0x3db504f3
    s_mov_b32 s12, 0x3fb8aa3b
    s_cmp_lt_u32 s2, 128
    s_cselect_b64 vcc, -1, 0
    v_mov_b32 v28, 148960
    s_mov_b32 s14, 1280000
    s_barrier
    s_waitcnt vmcnt(5)
    buffer_load_dwordx4 v4, s[44:47], s10 offen offset:2048 nt lds
    s_waitcnt vmcnt(5)
    buffer_load_dwordx4 v5, s[44:47], s10 offen offset:3072 nt lds
    s_xor_b32 s10, s7, 49152
    s_add_u32 m0, s9, 12288
    s_waitcnt vmcnt(5)
    buffer_load_dwordx4 v2, s[44:47], s10 offen offset:0 nt lds
    s_waitcnt vmcnt(5)
    buffer_load_dwordx4 v3, s[44:47], s10 offen offset:1024 nt lds
    s_waitcnt vmcnt(5)
    buffer_load_dwordx4 v4, s[44:47], s10 offen offset:2048 nt lds
    s_waitcnt vmcnt(5)
    buffer_load_dwordx4 v5, s[44:47], s10 offen offset:3072 nt lds
    s_xor_b32 s10, s7, 65536
    s_add_u32 m0, s9, 16384
    s_waitcnt vmcnt(5)
    buffer_load_dwordx4 v2, s[44:47], s10 offen offset:0 nt lds
    s_waitcnt vmcnt(5)
    buffer_load_dwordx4 v3, s[44:47], s10 offen offset:1024 nt lds
    s_waitcnt vmcnt(5)
    buffer_load_dwordx4 v4, s[44:47], s10 offen offset:2048 nt lds
    s_waitcnt vmcnt(5)
    buffer_load_dwordx4 v5, s[44:47], s10 offen offset:3072 nt lds
    s_xor_b32 s10, s7, 81920
    s_add_u32 m0, s9, 20480
    s_waitcnt vmcnt(5)
    buffer_load_dwordx4 v2, s[44:47], s10 offen offset:0 nt lds
    s_waitcnt vmcnt(5)
    buffer_load_dwordx4 v3, s[44:47], s10 offen offset:1024 nt lds
    s_waitcnt vmcnt(5)
    buffer_load_dwordx4 v4, s[44:47], s10 offen offset:2048 nt lds
    s_waitcnt vmcnt(5)
    buffer_load_dwordx4 v5, s[44:47], s10 offen offset:3072 nt lds
    s_xor_b32 s10, s7, 98304
    s_add_u32 m0, s9, 24576
    s_waitcnt vmcnt(5)
    buffer_load_dwordx4 v2, s[44:47], s10 offen offset:0 nt lds
    s_waitcnt vmcnt(5)
    buffer_load_dwordx4 v3, s[44:47], s10 offen offset:1024 nt lds
    s_waitcnt vmcnt(5)
    buffer_load_dwordx4 v4, s[44:47], s10 offen offset:2048 nt lds
    s_waitcnt vmcnt(5)
    buffer_load_dwordx4 v5, s[44:47], s10 offen offset:3072 nt lds
    s_xor_b32 s10, s7, 114688
    s_add_u32 m0, s9, 28672
    s_waitcnt vmcnt(5)
    buffer_load_dwordx4 v2, s[44:47], s10 offen offset:0 nt lds
    s_waitcnt vmcnt(5)
    buffer_load_dwordx4 v3, s[44:47], s10 offen offset:1024 nt lds
    s_waitcnt vmcnt(5)
    buffer_load_dwordx4 v4, s[44:47], s10 offen offset:2048 nt lds
    s_waitcnt vmcnt(5)
    buffer_load_dwordx4 v5, s[44:47], s10 offen offset:3072 nt lds
    s_xor_b32 s10, s7, 131072
    s_add_u32 m0, s9, 32768
    s_waitcnt vmcnt(5)
    buffer_load_dwordx4 v2, s[44:47], s10 offen offset:0 nt lds
    s_waitcnt vmcnt(5)
    buffer_load_dwordx4 v3, s[44:47], s10 offen offset:1024 nt lds
    s_waitcnt vmcnt(5)
    buffer_load_dwordx4 v4, s[44:47], s10 offen offset:2048 nt lds
    s_waitcnt vmcnt(5)
    buffer_load_dwordx4 v5, s[44:47], s10 offen offset:3072 nt lds
L_qf:
    ds_read_b32 v29, v28
    s_sub_u32 s14, s14, 1
    s_cbranch_scc1 L_qfd
    s_waitcnt lgkmcnt(0)
    v_readfirstlane_b32 s13, v29
    s_cmp_eq_u32 s13, -1
    s_nop 2
    s_cbranch_scc1 L_qf
L_qfd:
    v_mov_b32 v28, 148960
    ds_read_b32 v29, v28
    s_mov_b32 s15, 0
    ds_read_b128 v[32:35], v14 offset:0
    ds_read_b128 v[36:39], v14 offset:64
    ds_read_b128 v[40:43], v14 offset:128
    ds_read_b128 v[44:47], v14 offset:192
    ds_read_b128 v[112:115], v8 offset:0
    ds_read_b128 v[116:119], v9 offset:0
    ds_read_b128 v[120:123], v10 offset:0
    ds_read_b128 v[124:127], v11 offset:0
    ds_read_b128 v[48:51], v15 offset:0
    ds_read_b128 v[52:55], v15 offset:64
    ds_read_b128 v[56:59], v15 offset:128
    ds_read_b128 v[60:63], v15 offset:192
    s_waitcnt lgkmcnt(4)
    v_mfma_f32_16x16x32_bf16 v[96:99], v[112:115], v[32:35], 0
    v_mfma_f32_16x16x32_bf16 v[96:99], v[116:119], v[36:39], v[96:99]
    v_mfma_f32_16x16x32_bf16 v[96:99], v[120:123], v[40:43], v[96:99]
    v_mfma_f32_16x16x32_bf16 v[96:99], v[124:127], v[44:47], v[96:99]
    s_xor_b32 s10, s7, 147456
    s_add_u32 m0, s9, 0
    s_cbranch_vccnz L_w36
    s_waitcnt vmcnt(4)
L_w36:
    buffer_load_dwordx4 v2, s[44:47], s10 offen offset:0 nt lds
    ds_read_b128 v[128:131], v8 offset:4096
    ds_read_b128 v[132:135], v9 offset:4096
    ds_read_b128 v[136:139], v10 offset:4096
    ds_read_b128 v[140:143], v11 offset:4096
    ds_read_b128 v[64:67], v16 offset:0
    ds_read_b128 v[68:71], v16 offset:64
    ds_read_b128 v[72:75], v16 offset:128
    ds_read_b128 v[76:79], v16 offset:192
    s_waitcnt lgkmcnt(4)
    v_readfirstlane_b32 s13, v29
    v_mfma_f32_16x16x32_bf16 v[96:99], v[128:131], v[48:51], v[96:99]
    v_mfma_f32_16x16x32_bf16 v[96:99], v[132:135], v[52:55], v[96:99]
    v_mfma_f32_16x16x32_bf16 v[96:99], v[136:139], v[56:59], v[96:99]
    v_mfma_f32_16x16x32_bf16 v[96:99], v[140:143], v[60:63], v[96:99]
    s_cmp_lg_u32 s15, 0
    s_cbranch_scc1 L_w37
    s_waitcnt vmcnt(6)
    s_cbranch_vccnz L_w37
    s_waitcnt vmcnt(4)
L_w37:
    buffer_load_dwordx4 v3, s[44:47], s10 offen offset:1024 nt lds
    ds_read_b128 v[112:115], v8 offset:8192
    ds_read_b128 v[116:119], v9 offset:8192
    ds_read_b128 v[120:123], v10 offset:8192
    ds_read_b128 v[124:127], v11 offset:8192
    ds_read_b128 v[80:83], v17 offset:0
    ds_read_b128 v[84:87], v17 offset:64
    ds_read_b128 v[88:91], v17 offset:128
    ds_read_b128 v[92:95], v17 offset:192
    s_waitcnt lgkmcnt(4)
    v_mfma_f32_16x16x32_bf16 v[96:99], v[112:115], v[64:67], v[96:99]
    v_mfma_f32_16x16x32_bf16 v[96:99], v[116:119], v[68:71], v[96:99]
    v_mfma_f32_16x16x32_bf16 v[96:99], v[120:123], v[72:75], v[96:99]
    v_mfma_f32_16x16x32_bf16 v[96:99], v[124:127], v[76:79], v[96:99]
    s_cmp_lg_u32 s15, 0
    s_cbranch_scc1 L_w38
    s_waitcnt vmcnt(6)
    s_cbranch_vccnz L_w38
    s_waitcnt vmcnt(4)
L_w38:
    s_waitcnt vmcnt(7)
    buffer_load_dwordx4 v4, s[44:47], s10 offen offset:2048 nt lds
    s_memrealtime s[42:43]
    ds_read_b32 v29, v28
    ds_read_b128 v[128:131], v8 offset:12288
    ds_read_b128 v[132:135], v9 offset:12288
    ds_read_b128 v[136:139], v10 offset:12288
    ds_read_b128 v[140:143], v11 offset:12288
    s_waitcnt lgkmcnt(0)
    v_readfirstlane_b32 s13, v29
    s_sub_u32 s42, s42, s13
    s_cmp_gt_i32 s42, 710
    s_cselect_b64 vcc, -1, 0
    s_cmp_gt_i32 s42, 735
    s_cselect_b32 s15, 1, 0
    v_mfma_f32_16x16x32_bf16 v[96:99], v[128:131], v[80:83], v[96:99]
    v_mfma_f32_16x16x32_bf16 v[96:99], v[132:135], v[84:87], v[96:99]
    v_mfma_f32_16x16x32_bf16 v[96:99], v[136:139], v[88:91], v[96:99]
    v_mfma_f32_16x16x32_bf16 v[96:99], v[140:143], v[92:95], v[96:99]
    s_cmp_lg_u32 s15, 0
    s_cbranch_scc1 L_w39
    s_waitcnt vmcnt(6)
    s_cbranch_vccnz L_w39
    s_waitcnt vmcnt(4)
L_w39:
    s_waitcnt vmcnt(7)
    buffer_load_dwordx4 v5, s[44:47], s10 offen offset:3072 nt lds
    s_memrealtime s[42:43]
    ds_read_b32 v29, v28
    ds_read_b128 v[112:115], v8 offset:16384
    ds_read_b128 v[116:119], v9 offset:16384
    ds_read_b128 v[120:123], v10 offset:16384
    ds_read_b128 v[124:127], v11 offset:16384
    s_waitcnt lgkmcnt(0)
    v_readfirstlane_b32 s13, v29
    s_sub_u32 s42, s42, s13
    s_cmp_gt_i32 s42, 723
    s_cselect_b64 vcc, -1, 0
    s_cmp_gt_i32 s42, 748
    s_cselect_b32 s15, 1, 0
    v_mfma_f32_16x16x32_bf16 v[100:103], v[112:115], v[32:35], 0
    v_mfma_f32_16x16x32_bf16 v[100:103], v[116:119], v[36:39], v[100:103]
    v_mfma_f32_16x16x32_bf16 v[100:103], v[120:123], v[40:43], v[100:103]
    v_mfma_f32_16x16x32_bf16 v[100:103], v[124:127], v[44:47], v[100:103]
    v_cvt_pk_bf16_f32 v160, v96, v97
    v_cvt_pk_bf16_f32 v161, v98, v99
    v_lshlrev_b32 v96, 16, v160
    v_and_b32 v97, s6, v160
    v_lshlrev_b32 v98, 16, v161
    v_and_b32 v99, s6, v161
    v_mul_f32 v96, s11, v96
    v_mul_f32 v97, s11, v97
    v_mul_f32 v98, s11, v98
    v_mul_f32 v99, s11, v99
    v_cvt_pk_bf16_f32 v160, v96, v97
    v_cvt_pk_bf16_f32 v161, v98, v99
    v_lshlrev_b32 v96, 16, v160
    v_and_b32 v97, s6, v160
    v_lshlrev_b32 v98, 16, v161
    v_and_b32 v99, s6, v161
    v_max_f32 v168, v96, v97
    v_max3_f32 v168, v98, v99, v168
    s_xor_b32 s10, s7, 163840
    s_add_u32 m0, s9, 4096
    s_cmp_lg_u32 s15, 0
    s_cbranch_scc1 L_w40
    s_waitcnt vmcnt(6)
    s_cbranch_vccnz L_w40
    s_waitcnt vmcnt(4)
L_w40:
    s_waitcnt vmcnt(7)
    buffer_load_dwordx4 v2, s[44:47], s10 offen offset:0 nt lds
    s_memrealtime s[42:43]
    ds_read_b32 v29, v28
    ds_read_b128 v[128:131], v8 offset:20480
    ds_read_b128 v[132:135], v9 offset:20480
    ds_read_b128 v[136:139], v10 offset:20480
    ds_read_b128 v[140:143], v11 offset:20480
    s_waitcnt lgkmcnt(0)
    v_readfirstlane_b32 s13, v29
    s_sub_u32 s42, s42, s13
    s_cmp_gt_i32 s42, 737
    s_cselect_b64 vcc, -1, 0
    s_cmp_gt_i32 s42, 762
    s_cselect_b32 s15, 1, 0
    v_mfma_f32_16x16x32_bf16 v[100:103], v[128:131], v[48:51], v[100:103]
    v_mfma_f32_16x16x32_bf16 v[100:103], v[132:135], v[52:55], v[100:103]
    v_mfma_f32_16x16x32_bf16 v[100:103], v[136:139], v[56:59], v[100:103]
    v_mfma_f32_16x16x32_bf16 v[100:103], v[140:143], v[60:63], v[100:103]
    s_cmp_lg_u32 s15, 0
    s_cbranch_scc1 L_w41
    s_waitcnt vmcnt(6)
    s_cbranch_vccnz L_w41
    s_waitcnt vmcnt(4)
L_w41:
    s_waitcnt vmcnt(7)
    buffer_load_dwordx4 v3, s[44:47], s10 offen offset:1024 nt lds
    s_memrealtime s[42:43]
    ds_read_b32 v29, v28
    ds_read_b128 v[112:115], v8 offset:24576
    ds_read_b128 v[116:119], v9 offset:24576
    ds_read_b128 v[120:123], v10 offset:24576
    ds_read_b128 v[124:127], v11 offset:24576
    s_waitcnt lgkmcnt(0)
    v_readfirstlane_b32 s13, v29
    s_sub_u32 s42, s42, s13
    s_cmp_gt_i32 s42, 751
    s_cselect_b64 vcc, -1, 0
    s_cmp_gt_i32 s42, 776
    s_cselect_b32 s15, 1, 0
    v_mfma_f32_16x16x32_bf16 v[100:103], v[112:115], v[64:67], v[100:103]
    v_mfma_f32_16x16x32_bf16 v[100:103], v[116:119], v[68:71], v[100:103]
    v_mfma_f32_16x16x32_bf16 v[100:103], v[120:123], v[72:75], v[100:103]
    v_mfma_f32_16x16x32_bf16 v[100:103], v[124:127], v[76:79], v[100:103]
    s_cmp_lg_u32 s15, 0
    s_cbranch_scc1 L_w42
    s_waitcnt vmcnt(6)
    s_cbranch_vccnz L_w42
    s_waitcnt vmcnt(4)
L_w42:
    s_waitcnt vmcnt(7)
    buffer_load_dwordx4 v4, s[44:47], s10 offen offset:2048 nt lds
    s_memrealtime s[42:43]
    ds_read_b128 v[128:131], v8 offset:28672
    ds_read_b128 v[132:135], v9 offset:28672
    ds_read_b128 v[136:139], v10 offset:28672
    ds_read_b128 v[140:143], v11 offset:28672
    s_waitcnt lgkmcnt(0)
    s_sub_u32 s42, s42, s13
    s_cmp_gt_i32 s42, 765
    s_cselect_b64 vcc, -1, 0
    s_cmp_gt_i32 s42, 790
    s_cselect_b32 s15, 1, 0
    v_mfma_f32_16x16x32_bf16 v[100:103], v[128:131], v[80:83], v[100:103]
    v_mfma_f32_16x16x32_bf16 v[100:103], v[132:135], v[84:87], v[100:103]
    v_mfma_f32_16x16x32_bf16 v[100:103], v[136:139], v[88:91], v[100:103]
    v_mfma_f32_16x16x32_bf16 v[100:103], v[140:143], v[92:95], v[100:103]
    s_cmp_lg_u32 s15, 0
    s_cbranch_scc1 L_w43
    s_waitcnt vmcnt(6)
    s_cbranch_vccnz L_w43
    s_waitcnt vmcnt(4)
L_w43:
    s_waitcnt vmcnt(7)
    buffer_load_dwordx4 v5, s[44:47], s10 offen offset:3072 nt lds
    s_memrealtime s[42:43]
    ds_read_b128 v[112:115], v8 offset:32768
    ds_read_b128 v[116:119], v9 offset:32768
    ds_read_b128 v[120:123], v10 offset:32768
    ds_read_b128 v[124:127], v11 offset:32768
    s_waitcnt lgkmcnt(0)
    s_sub_u32 s42, s42, s13
    s_cmp_gt_i32 s42, 779
    s_cselect_b64 vcc, -1, 0
    s_cmp_gt_i32 s42, 804
    s_cselect_b32 s15, 1, 0
    v_mfma_f32_16x16x32_bf16 v[104:107], v[112:115], v[32:35], 0
    v_mfma_f32_16x16x32_bf16 v[104:107], v[116:119], v[36:39], v[104:107]
    v_mfma_f32_16x16x32_bf16 v[104:107], v[120:123], v[40:43], v[104:107]
    v_mfma_f32_16x16x32_bf16 v[104:107], v[124:127], v[44:47], v[104:107]
    v_cvt_pk_bf16_f32 v160, v100, v101
    v_cvt_pk_bf16_f32 v161, v102, v103
    v_lshlrev_b32 v100, 16, v160
    v_and_b32 v101, s6, v160
    v_lshlrev_b32 v102, 16, v161
    v_and_b32 v103, s6, v161
    v_mul_f32 v100, s11, v100
    v_mul_f32 v101, s11, v101
    v_mul_f32 v102, s11, v102
    v_mul_f32 v103, s11, v103
    v_cvt_pk_bf16_f32 v160, v100, v101
    v_cvt_pk_bf16_f32 v161, v102, v103
    v_lshlrev_b32 v100, 16, v160
    v_and_b32 v101, s6, v160
    v_lshlrev_b32 v102, 16, v161
    v_and_b32 v103, s6, v161
    v_max3_f32 v168, v100, v101, v168
    v_max3_f32 v168, v102, v103, v168
    s_xor_b32 s10, s7, 180224
    s_add_u32 m0, s9, 8192
    s_cmp_lg_u32 s15, 0
    s_cbranch_scc1 L_w44
    s_waitcnt vmcnt(6)
    s_cbranch_vccnz L_w44
    s_waitcnt vmcnt(4)
L_w44:
    s_waitcnt vmcnt(7)
    buffer_load_dwordx4 v2, s[44:47], s10 offen offset:0 nt lds
    s_cmp_lg_u32 s15, 0
    s_cbranch_scc1 L_w45
    s_waitcnt vmcnt(6)
    s_cbranch_vccnz L_w45
    s_waitcnt vmcnt(4)
L_w45:
    s_waitcnt vmcnt(7)
    buffer_load_dwordx4 v3, s[44:47], s10 offen offset:1024 nt lds
    s_cmp_lg_u32 s15, 0
    s_cbranch_scc1 L_w46
    s_waitcnt vmcnt(6)
    s_cbranch_vccnz L_w46
    s_waitcnt vmcnt(4)
L_w46:
    s_waitcnt vmcnt(7)
    buffer_load_dwordx4 v4, s[44:47], s10 offen offset:2048 nt lds
    s_cmp_lg_u32 s15, 0
    s_cbranch_scc1 L_w47
    s_waitcnt vmcnt(6)
    s_cbranch_vccnz L_w47
    s_waitcnt vmcnt(4)
L_w47:
    s_waitcnt vmcnt(7)
    buffer_load_dwordx4 v5, s[44:47], s10 offen offset:3072 nt lds
    s_memrealtime s[42:43]
    ds_read_b128 v[128:131], v8 offset:0
    ds_read_b128 v[132:135], v9 offset:0
    ds_read_b128 v[136:139], v10 offset:0
    ds_read_b128 v[140:143], v11 offset:0
    s_waitcnt lgkmcnt(0)
    s_sub_u32 s42, s42, s13
    s_cmp_gt_i32 s42, 834
    s_cselect_b64 vcc, -1, 0
    s_cmp_gt_i32 s42, 859
    s_cselect_b32 s15, 1, 0
    v_mfma_f32_16x16x32_bf16 v[104:107], v[128:131], v[48:51], v[104:107]
    v_mfma_f32_16x16x32_bf16 v[104:107], v[132:135], v[52:55], v[104:107]
    v_mfma_f32_16x16x32_bf16 v[104:107], v[136:139], v[56:59], v[104:107]
    v_mfma_f32_16x16x32_bf16 v[104:107], v[140:143], v[60:63], v[104:107]
    s_xor_b32 s10, s7, 196608
    s_add_u32 m0, s9, 12288
    s_cmp_lg_u32 s15, 0
    s_cbranch_scc1 L_w48
    s_waitcnt vmcnt(6)
    s_cbranch_vccnz L_w48
    s_waitcnt vmcnt(4)
L_w48:
    s_waitcnt vmcnt(7)
    buffer_load_dwordx4 v2, s[44:47], s10 offen offset:0 nt lds
    s_cmp_lg_u32 s15, 0
    s_cbranch_scc1 L_w49
    s_waitcnt vmcnt(6)
    s_cbranch_vccnz L_w49
    s_waitcnt vmcnt(4)
L_w49:
    s_waitcnt vmcnt(7)
    buffer_load_dwordx4 v3, s[44:47], s10 offen offset:1024 nt lds
    s_cmp_lg_u32 s15, 0
    s_cbranch_scc1 L_w50
    s_waitcnt vmcnt(6)
    s_cbranch_vccnz L_w50
    s_waitcnt vmcnt(4)
L_w50:
    s_waitcnt vmcnt(7)
    buffer_load_dwordx4 v4, s[44:47], s10 offen offset:2048 nt lds
    s_cmp_lg_u32 s15, 0
    s_cbranch_scc1 L_w51
    s_waitcnt vmcnt(6)
    s_cbranch_vccnz L_w51
    s_waitcnt vmcnt(4)
L_w51:
    s_waitcnt vmcnt(7)
    buffer_load_dwordx4 v5, s[44:47], s10 offen offset:3072 nt lds
    s_memrealtime s[42:43]
    ds_read_b128 v[112:115], v8 offset:4096
    ds_read_b128 v[116:119], v9 offset:4096
    ds_read_b128 v[120:123], v10 offset:4096
    ds_read_b128 v[124:127], v11 offset:4096
    s_waitcnt lgkmcnt(0)
    s_sub_u32 s42, s42, s13
    s_cmp_gt_i32 s42, 889
    s_cselect_b64 vcc, -1, 0
    s_cmp_gt_i32 s42, 914
    s_cselect_b32 s15, 1, 0
    v_mfma_f32_16x16x32_bf16 v[104:107], v[112:115], v[64:67], v[104:107]
    v_mfma_f32_16x16x32_bf16 v[104:107], v[116:119], v[68:71], v[104:107]
    v_mfma_f32_16x16x32_bf16 v[104:107], v[120:123], v[72:75], v[104:107]
    v_mfma_f32_16x16x32_bf16 v[104:107], v[124:127], v[76:79], v[104:107]
    s_xor_b32 s10, s7, 212992
    s_add_u32 m0, s9, 16384
    s_cmp_lg_u32 s15, 0
    s_cbranch_scc1 L_w52
    s_waitcnt vmcnt(6)
    s_cbranch_vccnz L_w52
    s_waitcnt vmcnt(4)
L_w52:
    s_waitcnt vmcnt(7)
    buffer_load_dwordx4 v2, s[44:47], s10 offen offset:0 nt lds
    s_cmp_lg_u32 s15, 0
    s_cbranch_scc1 L_w53
    s_waitcnt vmcnt(6)
    s_cbranch_vccnz L_w53
    s_waitcnt vmcnt(4)
L_w53:
    s_waitcnt vmcnt(7)
    buffer_load_dwordx4 v3, s[44:47], s10 offen offset:1024 nt lds
    s_cmp_lg_u32 s15, 0
    s_cbranch_scc1 L_w54
    s_waitcnt vmcnt(6)
    s_cbranch_vccnz L_w54
    s_waitcnt vmcnt(4)
L_w54:
    s_waitcnt vmcnt(7)
    buffer_load_dwordx4 v4, s[44:47], s10 offen offset:2048 nt lds
    s_cmp_lg_u32 s15, 0
    s_cbranch_scc1 L_w55
    s_waitcnt vmcnt(6)
    s_cbranch_vccnz L_w55
    s_waitcnt vmcnt(4)
L_w55:
    s_waitcnt vmcnt(7)
    buffer_load_dwordx4 v5, s[44:47], s10 offen offset:3072 nt lds
    s_memrealtime s[42:43]
    ds_read_b128 v[128:131], v8 offset:8192
    ds_read_b128 v[132:135], v9 offset:8192
    ds_read_b128 v[136:139], v10 offset:8192
    ds_read_b128 v[140:143], v11 offset:8192
    s_waitcnt lgkmcnt(0)
    s_sub_u32 s42, s42, s13
    s_cmp_gt_i32 s42, 944
    s_cselect_b64 vcc, -1, 0
    s_cmp_gt_i32 s42, 969
    s_cselect_b32 s15, 1, 0
    v_mfma_f32_16x16x32_bf16 v[104:107], v[128:131], v[80:83], v[104:107]
    v_mfma_f32_16x16x32_bf16 v[104:107], v[132:135], v[84:87], v[104:107]
    v_mfma_f32_16x16x32_bf16 v[104:107], v[136:139], v[88:91], v[104:107]
    v_mfma_f32_16x16x32_bf16 v[104:107], v[140:143], v[92:95], v[104:107]
    s_xor_b32 s10, s7, 229376
    s_add_u32 m0, s9, 20480
    s_cmp_lg_u32 s15, 0
    s_cbranch_scc1 L_w56
    s_waitcnt vmcnt(6)
    s_cbranch_vccnz L_w56
    s_waitcnt vmcnt(4)
L_w56:
    s_waitcnt vmcnt(7)
    buffer_load_dwordx4 v2, s[44:47], s10 offen offset:0 nt lds
    s_cmp_lg_u32 s15, 0
    s_cbranch_scc1 L_w57
    s_waitcnt vmcnt(6)
    s_cbranch_vccnz L_w57
    s_waitcnt vmcnt(4)
L_w57:
    s_waitcnt vmcnt(7)
    buffer_load_dwordx4 v3, s[44:47], s10 offen offset:1024 nt lds
    s_cmp_lg_u32 s15, 0
    s_cbranch_scc1 L_w58
    s_waitcnt vmcnt(6)
    s_cbranch_vccnz L_w58
    s_waitcnt vmcnt(4)
L_w58:
    s_waitcnt vmcnt(7)
    buffer_load_dwordx4 v4, s[44:47], s10 offen offset:2048 nt lds
    s_cmp_lg_u32 s15, 0
    s_cbranch_scc1 L_w59
    s_waitcnt vmcnt(6)
    s_cbranch_vccnz L_w59
    s_waitcnt vmcnt(4)
L_w59:
    s_waitcnt vmcnt(7)
    buffer_load_dwordx4 v5, s[44:47], s10 offen offset:3072 nt lds
    s_memrealtime s[42:43]
    ds_read_b128 v[112:115], v8 offset:12288
    ds_read_b128 v[116:119], v9 offset:12288
    ds_read_b128 v[120:123], v10 offset:12288
    ds_read_b128 v[124:127], v11 offset:12288
    s_waitcnt lgkmcnt(0)
    s_sub_u32 s42, s42, s13
    s_cmp_gt_i32 s42, 999
    s_cselect_b64 vcc, -1, 0
    s_cmp_gt_i32 s42, 1024
    s_cselect_b32 s15, 1, 0
    v_mfma_f32_16x16x32_bf16 v[108:111], v[112:115], v[32:35], 0
    v_mfma_f32_16x16x32_bf16 v[108:111], v[116:119], v[36:39], v[108:111]
    v_mfma_f32_16x16x32_bf16 v[108:111], v[120:123], v[40:43], v[108:111]
    v_mfma_f32_16x16x32_bf16 v[108:111], v[124:127], v[44:47], v[108:111]
    v_cvt_pk_bf16_f32 v160, v104, v105
    v_cvt_pk_bf16_f32 v161, v106, v107
    v_lshlrev_b32 v104, 16, v160
    v_and_b32 v105, s6, v160
    v_lshlrev_b32 v106, 16, v161
    v_and_b32 v107, s6, v161
    v_mul_f32 v104, s11, v104
    v_mul_f32 v105, s11, v105
    v_mul_f32 v106, s11, v106
    v_mul_f32 v107, s11, v107
    v_cvt_pk_bf16_f32 v160, v104, v105
    v_cvt_pk_bf16_f32 v161, v106, v107
    v_lshlrev_b32 v104, 16, v160
    v_and_b32 v105, s6, v160
    v_lshlrev_b32 v106, 16, v161
    v_and_b32 v107, s6, v161
    v_max3_f32 v168, v104, v105, v168
    v_max3_f32 v168, v106, v107, v168
    s_xor_b32 s10, s7, 245760
    s_add_u32 m0, s9, 24576
    s_cmp_lg_u32 s15, 0
    s_cbranch_scc1 L_w60
    s_waitcnt vmcnt(6)
    s_cbranch_vccnz L_w60
    s_waitcnt vmcnt(4)
L_w60:
    s_waitcnt vmcnt(7)
    buffer_load_dwordx4 v2, s[44:47], s10 offen offset:0 nt lds
    s_cmp_lg_u32 s15, 0
    s_cbranch_scc1 L_w61
    s_waitcnt vmcnt(6)
    s_cbranch_vccnz L_w61
    s_waitcnt vmcnt(4)
L_w61:
    s_waitcnt vmcnt(7)
    buffer_load_dwordx4 v3, s[44:47], s10 offen offset:1024 nt lds
    s_cmp_lg_u32 s15, 0
    s_cbranch_scc1 L_w62
    s_waitcnt vmcnt(6)
    s_cbranch_vccnz L_w62
    s_waitcnt vmcnt(4)
L_w62:
    s_waitcnt vmcnt(7)
    buffer_load_dwordx4 v4, s[44:47], s10 offen offset:2048 nt lds
    s_cmp_lg_u32 s15, 0
    s_cbranch_scc1 L_w63
    s_waitcnt vmcnt(6)
    s_cbranch_vccnz L_w63
    s_waitcnt vmcnt(4)
L_w63:
    s_waitcnt vmcnt(7)
    buffer_load_dwordx4 v5, s[44:47], s10 offen offset:3072 nt lds
    s_memrealtime s[42:43]
    ds_read_b128 v[128:131], v8 offset:16384
    ds_read_b128 v[132:135], v9 offset:16384
    ds_read_b128 v[136:139], v10 offset:16384
    ds_read_b128 v[140:143], v11 offset:16384
    s_waitcnt lgkmcnt(0)
    s_sub_u32 s42, s42, s13
    s_cmp_gt_i32 s42, 1055
    s_cselect_b64 vcc, -1, 0
    s_cmp_gt_i32 s42, 1080
    s_cselect_b32 s15, 1, 0
    v_mfma_f32_16x16x32_bf16 v[108:111], v[128:131], v[48:51], v[108:111]
    v_mfma_f32_16x16x32_bf16 v[108:111], v[132:135], v[52:55], v[108:111]
    v_mfma_f32_16x16x32_bf16 v[108:111], v[136:139], v[56:59], v[108:111]
    v_mfma_f32_16x16x32_bf16 v[108:111], v[140:143], v[60:63], v[108:111]
    s_xor_b32 s10, s7, 0
    s_add_u32 m0, s9, 28672
    s_cmp_lg_u32 s15, 0
    s_cbranch_scc1 L_w64
    s_waitcnt vmcnt(6)
    s_cbranch_vccnz L_w64
    s_waitcnt vmcnt(4)
L_w64:
    s_waitcnt vmcnt(7)
    buffer_load_dwordx4 v6, s[48:51], s10 offen offset:0 nt lds
    s_cmp_lg_u32 s15, 0
    s_cbranch_scc1 L_w65
    s_waitcnt vmcnt(6)
    s_cbranch_vccnz L_w65
    s_waitcnt vmcnt(4)
L_w65:
    s_waitcnt vmcnt(7)
    buffer_load_dwordx4 v6, s[48:51], s10 offen offset:1024 nt lds
    s_cmp_lg_u32 s15, 0
    s_cbranch_scc1 L_w66
    s_waitcnt vmcnt(6)
    s_cbranch_vccnz L_w66
    s_waitcnt vmcnt(4)
L_w66:
    s_waitcnt vmcnt(7)
    buffer_load_dwordx4 v6, s[48:51], s10 offen offset:2048 nt lds
    s_cmp_lg_u32 s15, 0
    s_cbranch_scc1 L_w67
    s_waitcnt vmcnt(6)
    s_cbranch_vccnz L_w67
    s_waitcnt vmcnt(4)
L_w67:
    s_waitcnt vmcnt(7)
    buffer_load_dwordx4 v6, s[48:51], s10 offen offset:3072 nt lds
    s_memrealtime s[42:43]
    ds_read_b128 v[112:115], v8 offset:20480
    ds_read_b128 v[116:119], v9 offset:20480
    ds_read_b128 v[120:123], v10 offset:20480
    ds_read_b128 v[124:127], v11 offset:20480
    s_waitcnt lgkmcnt(0)
    s_sub_u32 s42, s42, s13
    s_cmp_gt_i32 s42, 1110
    s_cselect_b64 vcc, -1, 0
    s_cmp_gt_i32 s42, 1135
    s_cselect_b32 s15, 1, 0
    v_mfma_f32_16x16x32_bf16 v[108:111], v[112:115], v[64:67], v[108:111]
    v_mfma_f32_16x16x32_bf16 v[108:111], v[116:119], v[68:71], v[108:111]
    v_mfma_f32_16x16x32_bf16 v[108:111], v[120:123], v[72:75], v[108:111]
    v_mfma_f32_16x16x32_bf16 v[108:111], v[124:127], v[76:79], v[108:111]
    s_xor_b32 s10, s7, 16384
    s_add_u32 m0, s9, 32768
    s_cmp_lg_u32 s15, 0
    s_cbranch_scc1 L_w68
    s_waitcnt vmcnt(6)
    s_cbranch_vccnz L_w68
    s_waitcnt vmcnt(4)
L_w68:
    s_waitcnt vmcnt(7)
    buffer_load_dwordx4 v6, s[48:51], s10 offen offset:0 nt lds
    s_cmp_lg_u32 s15, 0
    s_cbranch_scc1 L_w69
    s_waitcnt vmcnt(6)
    s_cbranch_vccnz L_w69
    s_waitcnt vmcnt(4)
L_w69:
    s_waitcnt vmcnt(7)
    buffer_load_dwordx4 v6, s[48:51], s10 offen offset:1024 nt lds
    s_cmp_lg_u32 s15, 0
    s_cbranch_scc1 L_w70
    s_waitcnt vmcnt(6)
    s_cbranch_vccnz L_w70
    s_waitcnt vmcnt(4)
L_w70:
    s_waitcnt vmcnt(7)
    buffer_load_dwordx4 v6, s[48:51], s10 offen offset:2048 nt lds
    s_cmp_lg_u32 s15, 0
    s_cbranch_scc1 L_w71
    s_waitcnt vmcnt(6)
    s_cbranch_vccnz L_w71
    s_waitcnt vmcnt(4)
L_w71:
    s_waitcnt vmcnt(7)
    buffer_load_dwordx4 v6, s[48:51], s10 offen offset:3072 nt lds
    s_memrealtime s[42:43]
    ds_read_b128 v[128:131], v8 offset:24576
    ds_read_b128 v[132:135], v9 offset:24576
    ds_read_b128 v[136:139], v10 offset:24576
    ds_read_b128 v[140:143], v11 offset:24576
    s_waitcnt lgkmcnt(0)
    s_sub_u32 s42, s42, s13
    s_cmp_gt_i32 s42, 1165
    s_cselect_b64 vcc, -1, 0
    s_cmp_gt_i32 s42, 1190
    s_cselect_b32 s15, 1, 0
    v_mfma_f32_16x16x32_bf16 v[108:111], v[128:131], v[80:83], v[108:111]
    v_mfma_f32_16x16x32_bf16 v[108:111], v[132:135], v[84:87], v[108:111]
    v_mfma_f32_16x16x32_bf16 v[108:111], v[136:139], v[88:91], v[108:111]
    v_mfma_f32_16x16x32_bf16 v[108:111], v[140:143], v[92:95], v[108:111]
    s_nop 7
    v_cvt_pk_bf16_f32 v160, v108, v109
    v_cvt_pk_bf16_f32 v161, v110, v111
    v_lshlrev_b32 v108, 16, v160
    v_and_b32 v109, s6, v160
    v_lshlrev_b32 v110, 16, v161
    v_and_b32 v111, s6, v161
    v_mul_f32 v108, s11, v108
    v_mul_f32 v109, s11, v109
    v_mul_f32 v110, s11, v110
    v_mul_f32 v111, s11, v111
    v_cvt_pk_bf16_f32 v160, v108, v109
    v_cvt_pk_bf16_f32 v161, v110, v111
    v_lshlrev_b32 v108, 16, v160
    v_and_b32 v109, s6, v160
    v_lshlrev_b32 v110, 16, v161
    v_and_b32 v111, s6, v161
    v_max3_f32 v168, v108, v109, v168
    v_max3_f32 v168, v110, v111, v168
    s_nop 1
    v_max_f32 v168, v168, v168 row_ror:4 row_mask:0xf bank_mask:0xf
    s_nop 1
    v_max_f32 v168, v168, v168 row_ror:8 row_mask:0xf bank_mask:0xf
    v_mov_b32 v160, v168
    s_nop 1
    v_permlane16_swap_b32 v168, v160
    v_max_f32 v168, v168, v160
    v_mov_b32 v160, v168
    s_nop 1
    v_permlane32_swap_b32 v168, v160
    v_max_f32 v168, v168, v160
    v_mul_f32 v162, s12, v168
    s_xor_b32 s10, s7, 32768
    s_add_u32 m0, s9, 0
    s_cmp_lg_u32 s15, 0
    s_cbranch_scc1 L_w72
    s_waitcnt vmcnt(6)
    s_cbranch_vccnz L_w72
    s_waitcnt vmcnt(4)
L_w72:
    s_waitcnt vmcnt(7)
    buffer_load_dwordx4 v6, s[48:51], s10 offen offset:0 nt lds
    v_fma_f32 v96, v96, s12, -v162
    v_fma_f32 v97, v97, s12, -v162
    v_fma_f32 v98, v98, s12, -v162
    v_fma_f32 v99, v99, s12, -v162
    v_exp_f32 v96, v96
    v_exp_f32 v97, v97
    v_exp_f32 v98, v98
    v_exp_f32 v99, v99
    v_cvt_pk_bf16_f32 v144, v96, v97
    v_cvt_pk_bf16_f32 v145, v98, v99
    v_add_f32 v160, v96, v97
    v_add_f32 v161, v98, v99
    v_add_f32 v169, v160, v161
    v_fma_f32 v100, v100, s12, -v162
    v_fma_f32 v101, v101, s12, -v162
    v_fma_f32 v102, v102, s12, -v162
    v_fma_f32 v103, v103, s12, -v162
    v_exp_f32 v100, v100
    v_exp_f32 v101, v101
    v_exp_f32 v102, v102
    v_exp_f32 v103, v103
    v_cvt_pk_bf16_f32 v146, v100, v101
    v_cvt_pk_bf16_f32 v147, v102, v103
    v_add_f32 v160, v100, v101
    v_add_f32 v161, v102, v103
    v_add_f32 v160, v160, v161
    v_add_f32 v169, v169, v160
    s_cmp_lg_u32 s15, 0
    s_cbranch_scc1 L_w73
    s_waitcnt vmcnt(6)
    s_cbranch_vccnz L_w73
    s_waitcnt vmcnt(4)
L_w73:
    s_waitcnt vmcnt(7)
    buffer_load_dwordx4 v6, s[48:51], s10 offen offset:1024 nt lds
    v_fma_f32 v104, v104, s12, -v162
    v_fma_f32 v105, v105, s12, -v162
    v_fma_f32 v106, v106, s12, -v162
    v_fma_f32 v107, v107, s12, -v162
    v_exp_f32 v104, v104
    v_exp_f32 v105, v105
    v_exp_f32 v106, v106
    v_exp_f32 v107, v107
    v_cvt_pk_bf16_f32 v148, v104, v105
    v_cvt_pk_bf16_f32 v149, v106, v107
    v_add_f32 v160, v104, v105
    v_add_f32 v161, v106, v107
    v_add_f32 v160, v160, v161
    v_add_f32 v169, v169, v160
    v_fma_f32 v108, v108, s12, -v162
    v_fma_f32 v109, v109, s12, -v162
    v_fma_f32 v110, v110, s12, -v162
    v_fma_f32 v111, v111, s12, -v162
    v_exp_f32 v108, v108
    v_exp_f32 v109, v109
    v_exp_f32 v110, v110
    v_exp_f32 v111, v111
    v_cvt_pk_bf16_f32 v150, v108, v109
    v_cvt_pk_bf16_f32 v151, v110, v111
    v_add_f32 v160, v108, v109
    v_add_f32 v161, v110, v111
    v_add_f32 v160, v160, v161
    v_add_f32 v169, v169, v160
    s_nop 1
    v_add_f32 v169, v169, v169 row_ror:4 row_mask:0xf bank_mask:0xf
    s_nop 1
    v_add_f32 v169, v169, v169 row_ror:8 row_mask:0xf bank_mask:0xf
    v_mov_b32 v160, v169
    s_nop 1
    v_permlane16_swap_b32 v169, v160
    v_add_f32 v169, v169, v160
    v_mov_b32 v160, v169
    s_nop 1
    v_permlane32_swap_b32 v169, v160
    v_add_f32 v169, v169, v160
    s_mov_b64 exec, 15
    ds_write_b64 v27, v[168:169]
    s_mov_b64 exec, -1
    s_cmp_lg_u32 s15, 0
    s_cbranch_scc1 L_w74
    s_waitcnt vmcnt(6)
    s_cbranch_vccnz L_w74
    s_waitcnt vmcnt(4)
L_w74:
    s_waitcnt vmcnt(7)
    buffer_load_dwordx4 v6, s[48:51], s10 offen offset:2048 nt lds
    s_cmp_lg_u32 s15, 0
    s_cbranch_scc1 L_w75
    s_waitcnt vmcnt(6)
    s_cbranch_vccnz L_w75
    s_waitcnt vmcnt(4)
L_w75:
    s_waitcnt vmcnt(7)
    buffer_load_dwordx4 v6, s[48:51], s10 offen offset:3072 nt lds
    s_memrealtime s[42:43]
    ds_read_b64_tr_b16 v[112:113], v12 offset:28672
    ds_read_b64_tr_b16 v[114:115], v13 offset:28672
    ds_read_b64_tr_b16 v[116:117], v12 offset:29696
    ds_read_b64_tr_b16 v[118:119], v13 offset:29696
    ds_read_b64_tr_b16 v[120:121], v12 offset:30720
    ds_read_b64_tr_b16 v[122:123], v13 offset:30720
    ds_read_b64_tr_b16 v[124:125], v12 offset:31744
    ds_read_b64_tr_b16 v[126:127], v13 offset:31744
    s_waitcnt lgkmcnt(0)
    s_sub_u32 s42, s42, s13
    s_cmp_gt_i32 s42, 1220
    s_cselect_b64 vcc, -1, 0
    s_cmp_gt_i32 s42, 1245
    s_cselect_b32 s15, 1, 0
    v_mfma_f32_4x4x4_16b_bf16 v[152:155], v[144:145], v[112:113], 0 cbsz:4 abid:0
    v_mfma_f32_4x4x4_16b_bf16 v[156:159], v[144:145], v[114:115], 0 cbsz:4 abid:0
    s_nop 0
    v_mfma_f32_4x4x4_16b_bf16 v[152:155], v[144:145], v[116:117], v[152:155] cbsz:4 abid:4
    v_mfma_f32_4x4x4_16b_bf16 v[156:159], v[144:145], v[118:119], v[156:159] cbsz:4 abid:4
    s_nop 0
    v_mfma_f32_4x4x4_16b_bf16 v[152:155], v[144:145], v[120:121], v[152:155] cbsz:4 abid:8
    v_mfma_f32_4x4x4_16b_bf16 v[156:159], v[144:145], v[122:123], v[156:159] cbsz:4 abid:8
    s_nop 0
    v_mfma_f32_4x4x4_16b_bf16 v[152:155], v[144:145], v[124:125], v[152:155] cbsz:4 abid:12
    v_mfma_f32_4x4x4_16b_bf16 v[156:159], v[144:145], v[126:127], v[156:159] cbsz:4 abid:12
    s_xor_b32 s10, s7, 49152
    s_add_u32 m0, s9, 4096
    s_cmp_lg_u32 s15, 0
    s_cbranch_scc1 L_w76
    s_waitcnt vmcnt(6)
    s_cbranch_vccnz L_w76
    s_waitcnt vmcnt(4)
L_w76:
    s_waitcnt vmcnt(7)
    buffer_load_dwordx4 v6, s[48:51], s10 offen offset:0 nt lds
    s_cmp_lg_u32 s15, 0
    s_cbranch_scc1 L_w77
    s_waitcnt vmcnt(6)
    s_cbranch_vccnz L_w77
    s_waitcnt vmcnt(4)
L_w77:
    s_waitcnt vmcnt(7)
    buffer_load_dwordx4 v6, s[48:51], s10 offen offset:1024 nt lds
    s_cmp_lg_u32 s15, 0
    s_cbranch_scc1 L_w78
    s_waitcnt vmcnt(6)
    s_cbranch_vccnz L_w78
    s_waitcnt vmcnt(4)
L_w78:
    s_waitcnt vmcnt(7)
    buffer_load_dwordx4 v6, s[48:51], s10 offen offset:2048 nt lds
    s_cmp_lg_u32 s15, 0
    s_cbranch_scc1 L_w79
    s_waitcnt vmcnt(6)
    s_cbranch_vccnz L_w79
    s_waitcnt vmcnt(4)
L_w79:
    s_waitcnt vmcnt(7)
    buffer_load_dwordx4 v6, s[48:51], s10 offen offset:3072 nt lds
    s_memrealtime s[42:43]
    ds_read_b64_tr_b16 v[128:129], v12 offset:32768
    ds_read_b64_tr_b16 v[130:131], v13 offset:32768
    ds_read_b64_tr_b16 v[132:133], v12 offset:33792
    ds_read_b64_tr_b16 v[134:135], v13 offset:33792
    ds_read_b64_tr_b16 v[136:137], v12 offset:34816
    ds_read_b64_tr_b16 v[138:139], v13 offset:34816
    ds_read_b64_tr_b16 v[140:141], v12 offset:35840
    ds_read_b64_tr_b16 v[142:143], v13 offset:35840
    s_waitcnt lgkmcnt(0)
    s_sub_u32 s42, s42, s13
    s_cmp_gt_i32 s42, 1276
    s_cselect_b64 vcc, -1, 0
    s_cmp_gt_i32 s42, 1301
    s_cselect_b32 s15, 1, 0
    v_mfma_f32_4x4x4_16b_bf16 v[152:155], v[144:145], v[128:129], v[152:155] cbsz:4 abid:1
    v_mfma_f32_4x4x4_16b_bf16 v[156:159], v[144:145], v[130:131], v[156:159] cbsz:4 abid:1
    s_nop 0
    v_mfma_f32_4x4x4_16b_bf16 v[152:155], v[144:145], v[132:133], v[152:155] cbsz:4 abid:5
    v_mfma_f32_4x4x4_16b_bf16 v[156:159], v[144:145], v[134:135], v[156:159] cbsz:4 abid:5
    s_nop 0
    v_mfma_f32_4x4x4_16b_bf16 v[152:155], v[144:145], v[136:137], v[152:155] cbsz:4 abid:9
    v_mfma_f32_4x4x4_16b_bf16 v[156:159], v[144:145], v[138:139], v[156:159] cbsz:4 abid:9
    s_nop 0
    v_mfma_f32_4x4x4_16b_bf16 v[152:155], v[144:145], v[140:141], v[152:155] cbsz:4 abid:13
    v_mfma_f32_4x4x4_16b_bf16 v[156:159], v[144:145], v[142:143], v[156:159] cbsz:4 abid:13
    s_xor_b32 s10, s7, 65536
    s_add_u32 m0, s9, 8192
    s_cmp_lg_u32 s15, 0
    s_cbranch_scc1 L_w80
    s_waitcnt vmcnt(6)
    s_cbranch_vccnz L_w80
    s_waitcnt vmcnt(4)
L_w80:
    s_waitcnt vmcnt(7)
    buffer_load_dwordx4 v6, s[48:51], s10 offen offset:0 nt lds
    s_cmp_lg_u32 s15, 0
    s_cbranch_scc1 L_w81
    s_waitcnt vmcnt(6)
    s_cbranch_vccnz L_w81
    s_waitcnt vmcnt(4)
L_w81:
    s_waitcnt vmcnt(7)
    buffer_load_dwordx4 v6, s[48:51], s10 offen offset:1024 nt lds
    s_cmp_lg_u32 s15, 0
    s_cbranch_scc1 L_w82
    s_waitcnt vmcnt(6)
    s_cbranch_vccnz L_w82
    s_waitcnt vmcnt(4)
L_w82:
    s_waitcnt vmcnt(7)
    buffer_load_dwordx4 v6, s[48:51], s10 offen offset:2048 nt lds
    s_cmp_lg_u32 s15, 0
    s_cbranch_scc1 L_w83
    s_waitcnt vmcnt(6)
    s_cbranch_vccnz L_w83
    s_waitcnt vmcnt(4)
L_w83:
    s_waitcnt vmcnt(7)
    buffer_load_dwordx4 v6, s[48:51], s10 offen offset:3072 nt lds
    s_memrealtime s[42:43]
    ds_read_b64_tr_b16 v[112:113], v12 offset:0
    ds_read_b64_tr_b16 v[114:115], v13 offset:0
    ds_read_b64_tr_b16 v[116:117], v12 offset:1024
    ds_read_b64_tr_b16 v[118:119], v13 offset:1024
    ds_read_b64_tr_b16 v[120:121], v12 offset:2048
    ds_read_b64_tr_b16 v[122:123], v13 offset:2048
    ds_read_b64_tr_b16 v[124:125], v12 offset:3072
    ds_read_b64_tr_b16 v[126:127], v13 offset:3072
    s_waitcnt lgkmcnt(0)
    s_sub_u32 s42, s42, s13
    s_cmp_gt_i32 s42, 1332
    s_cselect_b64 vcc, -1, 0
    s_cmp_gt_i32 s42, 1357
    s_cselect_b32 s15, 1, 0
    v_mfma_f32_4x4x4_16b_bf16 v[152:155], v[144:145], v[112:113], v[152:155] cbsz:4 abid:2
    v_mfma_f32_4x4x4_16b_bf16 v[156:159], v[144:145], v[114:115], v[156:159] cbsz:4 abid:2
    s_nop 0
    v_mfma_f32_4x4x4_16b_bf16 v[152:155], v[144:145], v[116:117], v[152:155] cbsz:4 abid:6
    v_mfma_f32_4x4x4_16b_bf16 v[156:159], v[144:145], v[118:119], v[156:159] cbsz:4 abid:6
    s_nop 0
    v_mfma_f32_4x4x4_16b_bf16 v[152:155], v[144:145], v[120:121], v[152:155] cbsz:4 abid:10
    v_mfma_f32_4x4x4_16b_bf16 v[156:159], v[144:145], v[122:123], v[156:159] cbsz:4 abid:10
    s_nop 0
    v_mfma_f32_4x4x4_16b_bf16 v[152:155], v[144:145], v[124:125], v[152:155] cbsz:4 abid:14
    v_mfma_f32_4x4x4_16b_bf16 v[156:159], v[144:145], v[126:127], v[156:159] cbsz:4 abid:14
    s_xor_b32 s10, s7, 81920
    s_add_u32 m0, s9, 12288
    s_cmp_lg_u32 s15, 0
    s_cbranch_scc1 L_w84
    s_waitcnt vmcnt(6)
    s_cbranch_vccnz L_w84
    s_waitcnt vmcnt(4)
L_w84:
    s_waitcnt vmcnt(7)
    buffer_load_dwordx4 v6, s[48:51], s10 offen offset:0 nt lds
    s_cmp_lg_u32 s15, 0
    s_cbranch_scc1 L_w85
    s_waitcnt vmcnt(6)
    s_cbranch_vccnz L_w85
    s_waitcnt vmcnt(4)
L_w85:
    s_waitcnt vmcnt(7)
    buffer_load_dwordx4 v6, s[48:51], s10 offen offset:1024 nt lds
    s_cmp_lg_u32 s15, 0
    s_cbranch_scc1 L_w86
    s_waitcnt vmcnt(6)
    s_cbranch_vccnz L_w86
    s_waitcnt vmcnt(4)
L_w86:
    s_waitcnt vmcnt(7)
    buffer_load_dwordx4 v6, s[48:51], s10 offen offset:2048 nt lds
    s_cmp_lg_u32 s15, 0
    s_cbranch_scc1 L_w87
    s_waitcnt vmcnt(6)
    s_cbranch_vccnz L_w87
    s_waitcnt vmcnt(4)
L_w87:
    s_waitcnt vmcnt(7)
    buffer_load_dwordx4 v6, s[48:51], s10 offen offset:3072 nt lds
    s_memrealtime s[42:43]
    ds_read_b64_tr_b16 v[128:129], v12 offset:4096
    ds_read_b64_tr_b16 v[130:131], v13 offset:4096
    ds_read_b64_tr_b16 v[132:133], v12 offset:5120
    ds_read_b64_tr_b16 v[134:135], v13 offset:5120
    ds_read_b64_tr_b16 v[136:137], v12 offset:6144
    ds_read_b64_tr_b16 v[138:139], v13 offset:6144
    ds_read_b64_tr_b16 v[140:141], v12 offset:7168
    ds_read_b64_tr_b16 v[142:143], v13 offset:7168
    s_waitcnt lgkmcnt(0)
    s_sub_u32 s42, s42, s13
    s_cmp_gt_i32 s42, 1387
    s_cselect_b64 vcc, -1, 0
    s_cmp_gt_i32 s42, 1412
    s_cselect_b32 s15, 1, 0
    v_mfma_f32_4x4x4_16b_bf16 v[152:155], v[144:145], v[128:129], v[152:155] cbsz:4 abid:3
    v_mfma_f32_4x4x4_16b_bf16 v[156:159], v[144:145], v[130:131], v[156:159] cbsz:4 abid:3
    s_nop 0
    v_mfma_f32_4x4x4_16b_bf16 v[152:155], v[144:145], v[132:133], v[152:155] cbsz:4 abid:7
    v_mfma_f32_4x4x4_16b_bf16 v[156:159], v[144:145], v[134:135], v[156:159] cbsz:4 abid:7
    s_nop 0
    v_mfma_f32_4x4x4_16b_bf16 v[152:155], v[144:145], v[136:137], v[152:155] cbsz:4 abid:11
    v_mfma_f32_4x4x4_16b_bf16 v[156:159], v[144:145], v[138:139], v[156:159] cbsz:4 abid:11
    s_nop 0
    v_mfma_f32_4x4x4_16b_bf16 v[152:155], v[144:145], v[140:141], v[152:155] cbsz:4 abid:15
    v_mfma_f32_4x4x4_16b_bf16 v[156:159], v[144:145], v[142:143], v[156:159] cbsz:4 abid:15
    s_xor_b32 s10, s7, 98304
    s_add_u32 m0, s9, 16384
    s_cmp_lg_u32 s15, 0
    s_cbranch_scc1 L_w88
    s_waitcnt vmcnt(6)
    s_cbranch_vccnz L_w88
    s_waitcnt vmcnt(4)
L_w88:
    s_waitcnt vmcnt(7)
    buffer_load_dwordx4 v6, s[48:51], s10 offen offset:0 nt lds
    s_cmp_lg_u32 s15, 0
    s_cbranch_scc1 L_w89
    s_waitcnt vmcnt(6)
    s_cbranch_vccnz L_w89
    s_waitcnt vmcnt(4)
L_w89:
    s_waitcnt vmcnt(7)
    buffer_load_dwordx4 v6, s[48:51], s10 offen offset:1024 nt lds
    s_cmp_lg_u32 s15, 0
    s_cbranch_scc1 L_w90
    s_waitcnt vmcnt(6)
    s_cbranch_vccnz L_w90
    s_waitcnt vmcnt(4)
L_w90:
    s_waitcnt vmcnt(7)
    buffer_load_dwordx4 v6, s[48:51], s10 offen offset:2048 nt lds
    s_cmp_lg_u32 s15, 0
    s_cbranch_scc1 L_w91
    s_waitcnt vmcnt(6)
    s_cbranch_vccnz L_w91
    s_waitcnt vmcnt(4)
L_w91:
    s_waitcnt vmcnt(7)
    buffer_load_dwordx4 v6, s[48:51], s10 offen offset:3072 nt lds
    s_memrealtime s[42:43]
    ds_read_b64_tr_b16 v[112:113], v12 offset:8192
    ds_read_b64_tr_b16 v[114:115], v13 offset:8192
    ds_read_b64_tr_b16 v[116:117], v12 offset:9216
    ds_read_b64_tr_b16 v[118:119], v13 offset:9216
    ds_read_b64_tr_b16 v[120:121], v12 offset:10240
    ds_read_b64_tr_b16 v[122:123], v13 offset:10240
    ds_read_b64_tr_b16 v[124:125], v12 offset:11264
    ds_read_b64_tr_b16 v[126:127], v13 offset:11264
    s_waitcnt lgkmcnt(0)
    s_sub_u32 s42, s42, s13
    s_cmp_gt_i32 s42, 1443
    s_cselect_b64 vcc, -1, 0
    s_cmp_gt_i32 s42, 1468
    s_cselect_b32 s15, 1, 0
    v_mfma_f32_4x4x4_16b_bf16 v[152:155], v[146:147], v[112:113], v[152:155] cbsz:4 abid:0
    v_mfma_f32_4x4x4_16b_bf16 v[156:159], v[146:147], v[114:115], v[156:159] cbsz:4 abid:0
    s_nop 0
    v_mfma_f32_4x4x4_16b_bf16 v[152:155], v[146:147], v[116:117], v[152:155] cbsz:4 abid:4
    v_mfma_f32_4x4x4_16b_bf16 v[156:159], v[146:147], v[118:119], v[156:159] cbsz:4 abid:4
    s_nop 0
    v_mfma_f32_4x4x4_16b_bf16 v[152:155], v[146:147], v[120:121], v[152:155] cbsz:4 abid:8
    v_mfma_f32_4x4x4_16b_bf16 v[156:159], v[146:147], v[122:123], v[156:159] cbsz:4 abid:8
    s_nop 0
    v_mfma_f32_4x4x4_16b_bf16 v[152:155], v[146:147], v[124:125], v[152:155] cbsz:4 abid:12
    v_mfma_f32_4x4x4_16b_bf16 v[156:159], v[146:147], v[126:127], v[156:159] cbsz:4 abid:12
    s_xor_b32 s10, s7, 114688
    s_add_u32 m0, s9, 20480
    s_cmp_lg_u32 s15, 0
    s_cbranch_scc1 L_w92
    s_waitcnt vmcnt(6)
    s_cbranch_vccnz L_w92
    s_waitcnt vmcnt(4)
L_w92:
    s_waitcnt vmcnt(7)
    buffer_load_dwordx4 v6, s[48:51], s10 offen offset:0 nt lds
    s_cmp_lg_u32 s15, 0
    s_cbranch_scc1 L_w93
    s_waitcnt vmcnt(6)
    s_cbranch_vccnz L_w93
    s_waitcnt vmcnt(4)
L_w93:
    s_waitcnt vmcnt(7)
    buffer_load_dwordx4 v6, s[48:51], s10 offen offset:1024 nt lds
    s_cmp_lg_u32 s15, 0
    s_cbranch_scc1 L_w94
    s_waitcnt vmcnt(6)
    s_cbranch_vccnz L_w94
    s_waitcnt vmcnt(4)
L_w94:
    s_waitcnt vmcnt(7)
    buffer_load_dwordx4 v6, s[48:51], s10 offen offset:2048 nt lds
    s_cmp_lg_u32 s15, 0
    s_cbranch_scc1 L_w95
    s_waitcnt vmcnt(6)
    s_cbranch_vccnz L_w95
    s_waitcnt vmcnt(4)
L_w95:
    s_waitcnt vmcnt(7)
    buffer_load_dwordx4 v6, s[48:51], s10 offen offset:3072 nt lds
    s_memrealtime s[42:43]
    ds_read_b64_tr_b16 v[128:129], v12 offset:12288
    ds_read_b64_tr_b16 v[130:131], v13 offset:12288
    ds_read_b64_tr_b16 v[132:133], v12 offset:13312
    ds_read_b64_tr_b16 v[134:135], v13 offset:13312
    ds_read_b64_tr_b16 v[136:137], v12 offset:14336
    ds_read_b64_tr_b16 v[138:139], v13 offset:14336
    ds_read_b64_tr_b16 v[140:141], v12 offset:15360
    ds_read_b64_tr_b16 v[142:143], v13 offset:15360
    s_waitcnt lgkmcnt(0)
    s_sub_u32 s42, s42, s13
    s_cmp_gt_i32 s42, 1498
    s_cselect_b64 vcc, -1, 0
    s_cmp_gt_i32 s42, 1523
    s_cselect_b32 s15, 1, 0
    v_mfma_f32_4x4x4_16b_bf16 v[152:155], v[146:147], v[128:129], v[152:155] cbsz:4 abid:1
    v_mfma_f32_4x4x4_16b_bf16 v[156:159], v[146:147], v[130:131], v[156:159] cbsz:4 abid:1
    s_nop 0
    v_mfma_f32_4x4x4_16b_bf16 v[152:155], v[146:147], v[132:133], v[152:155] cbsz:4 abid:5
    v_mfma_f32_4x4x4_16b_bf16 v[156:159], v[146:147], v[134:135], v[156:159] cbsz:4 abid:5
    s_nop 0
    v_mfma_f32_4x4x4_16b_bf16 v[152:155], v[146:147], v[136:137], v[152:155] cbsz:4 abid:9
    v_mfma_f32_4x4x4_16b_bf16 v[156:159], v[146:147], v[138:139], v[156:159] cbsz:4 abid:9
    s_nop 0
    v_mfma_f32_4x4x4_16b_bf16 v[152:155], v[146:147], v[140:141], v[152:155] cbsz:4 abid:13
    v_mfma_f32_4x4x4_16b_bf16 v[156:159], v[146:147], v[142:143], v[156:159] cbsz:4 abid:13
    s_xor_b32 s10, s7, 131072
    s_add_u32 m0, s9, 24576
    s_cmp_lg_u32 s15, 0
    s_cbranch_scc1 L_w96
    s_waitcnt vmcnt(6)
    s_cbranch_vccnz L_w96
    s_waitcnt vmcnt(4)
L_w96:
    s_waitcnt vmcnt(7)
    buffer_load_dwordx4 v6, s[48:51], s10 offen offset:0 nt lds
    s_cmp_lg_u32 s15, 0
    s_cbranch_scc1 L_w97
    s_waitcnt vmcnt(6)
    s_cbranch_vccnz L_w97
    s_waitcnt vmcnt(4)
L_w97:
    s_waitcnt vmcnt(7)
    buffer_load_dwordx4 v6, s[48:51], s10 offen offset:1024 nt lds
    s_cmp_lg_u32 s15, 0
    s_cbranch_scc1 L_w98
    s_waitcnt vmcnt(6)
    s_cbranch_vccnz L_w98
    s_waitcnt vmcnt(4)
L_w98:
    s_waitcnt vmcnt(7)
    buffer_load_dwordx4 v6, s[48:51], s10 offen offset:2048 nt lds
    s_cmp_lg_u32 s15, 0
    s_cbranch_scc1 L_w99
    s_waitcnt vmcnt(6)
    s_cbranch_vccnz L_w99
    s_waitcnt vmcnt(4)
L_w99:
    s_waitcnt vmcnt(7)
    buffer_load_dwordx4 v6, s[48:51], s10 offen offset:3072 nt lds
    s_memrealtime s[42:43]
    ds_read_b64_tr_b16 v[112:113], v12 offset:16384
    ds_read_b64_tr_b16 v[114:115], v13 offset:16384
    ds_read_b64_tr_b16 v[116:117], v12 offset:17408
    ds_read_b64_tr_b16 v[118:119], v13 offset:17408
    ds_read_b64_tr_b16 v[120:121], v12 offset:18432
    ds_read_b64_tr_b16 v[122:123], v13 offset:18432
    ds_read_b64_tr_b16 v[124:125], v12 offset:19456
    ds_read_b64_tr_b16 v[126:127], v13 offset:19456
    s_waitcnt lgkmcnt(0)
    s_sub_u32 s42, s42, s13
    s_cmp_gt_i32 s42, 1554
    s_cselect_b64 vcc, -1, 0
    s_cmp_gt_i32 s42, 1579
    s_cselect_b32 s15, 1, 0
    v_mfma_f32_4x4x4_16b_bf16 v[152:155], v[146:147], v[112:113], v[152:155] cbsz:4 abid:2
    v_mfma_f32_4x4x4_16b_bf16 v[156:159], v[146:147], v[114:115], v[156:159] cbsz:4 abid:2
    s_nop 0
    v_mfma_f32_4x4x4_16b_bf16 v[152:155], v[146:147], v[116:117], v[152:155] cbsz:4 abid:6
    v_mfma_f32_4x4x4_16b_bf16 v[156:159], v[146:147], v[118:119], v[156:159] cbsz:4 abid:6
    s_nop 0
    v_mfma_f32_4x4x4_16b_bf16 v[152:155], v[146:147], v[120:121], v[152:155] cbsz:4 abid:10
    v_mfma_f32_4x4x4_16b_bf16 v[156:159], v[146:147], v[122:123], v[156:159] cbsz:4 abid:10
    s_nop 0
    v_mfma_f32_4x4x4_16b_bf16 v[152:155], v[146:147], v[124:125], v[152:155] cbsz:4 abid:14
    v_mfma_f32_4x4x4_16b_bf16 v[156:159], v[146:147], v[126:127], v[156:159] cbsz:4 abid:14
    s_xor_b32 s10, s7, 147456
    s_add_u32 m0, s9, 28672
    s_cmp_lg_u32 s15, 0
    s_cbranch_scc1 L_w100
    s_waitcnt vmcnt(6)
    s_cbranch_vccnz L_w100
    s_waitcnt vmcnt(4)
L_w100:
    s_waitcnt vmcnt(7)
    buffer_load_dwordx4 v6, s[48:51], s10 offen offset:0 nt lds
    s_cmp_lg_u32 s15, 0
    s_cbranch_scc1 L_w101
    s_waitcnt vmcnt(6)
    s_cbranch_vccnz L_w101
    s_waitcnt vmcnt(4)
L_w101:
    s_waitcnt vmcnt(7)
    buffer_load_dwordx4 v6, s[48:51], s10 offen offset:1024 nt lds
    s_cmp_lg_u32 s15, 0
    s_cbranch_scc1 L_w102
    s_waitcnt vmcnt(6)
    s_cbranch_vccnz L_w102
    s_waitcnt vmcnt(4)
L_w102:
    s_waitcnt vmcnt(7)
    buffer_load_dwordx4 v6, s[48:51], s10 offen offset:2048 nt lds
    s_cmp_lg_u32 s15, 0
    s_cbranch_scc1 L_w103
    s_waitcnt vmcnt(6)
    s_cbranch_vccnz L_w103
    s_waitcnt vmcnt(4)
L_w103:
    s_waitcnt vmcnt(7)
    buffer_load_dwordx4 v6, s[48:51], s10 offen offset:3072 nt lds
    s_memrealtime s[42:43]
    ds_read_b64_tr_b16 v[128:129], v12 offset:20480
    ds_read_b64_tr_b16 v[130:131], v13 offset:20480
    ds_read_b64_tr_b16 v[132:133], v12 offset:21504
    ds_read_b64_tr_b16 v[134:135], v13 offset:21504
    ds_read_b64_tr_b16 v[136:137], v12 offset:22528
    ds_read_b64_tr_b16 v[138:139], v13 offset:22528
    ds_read_b64_tr_b16 v[140:141], v12 offset:23552
    ds_read_b64_tr_b16 v[142:143], v13 offset:23552
    s_waitcnt lgkmcnt(0)
    s_sub_u32 s42, s42, s13
    s_cmp_gt_i32 s42, 1610
    s_cselect_b64 vcc, -1, 0
    s_cmp_gt_i32 s42, 1635
    s_cselect_b32 s15, 1, 0
    v_mfma_f32_4x4x4_16b_bf16 v[152:155], v[146:147], v[128:129], v[152:155] cbsz:4 abid:3
    v_mfma_f32_4x4x4_16b_bf16 v[156:159], v[146:147], v[130:131], v[156:159] cbsz:4 abid:3
    s_nop 0
    v_mfma_f32_4x4x4_16b_bf16 v[152:155], v[146:147], v[132:133], v[152:155] cbsz:4 abid:7
    v_mfma_f32_4x4x4_16b_bf16 v[156:159], v[146:147], v[134:135], v[156:159] cbsz:4 abid:7
    s_nop 0
    v_mfma_f32_4x4x4_16b_bf16 v[152:155], v[146:147], v[136:137], v[152:155] cbsz:4 abid:11
    v_mfma_f32_4x4x4_16b_bf16 v[156:159], v[146:147], v[138:139], v[156:159] cbsz:4 abid:11
    s_nop 0
    v_mfma_f32_4x4x4_16b_bf16 v[152:155], v[146:147], v[140:141], v[152:155] cbsz:4 abid:15
    v_mfma_f32_4x4x4_16b_bf16 v[156:159], v[146:147], v[142:143], v[156:159] cbsz:4 abid:15
    s_xor_b32 s10, s7, 163840
    s_add_u32 m0, s9, 32768
    s_cmp_lg_u32 s15, 0
    s_cbranch_scc1 L_w104
    s_waitcnt vmcnt(6)
    s_cbranch_vccnz L_w104
    s_waitcnt vmcnt(4)
L_w104:
    s_waitcnt vmcnt(7)
    buffer_load_dwordx4 v6, s[48:51], s10 offen offset:0 nt lds
    s_cmp_lg_u32 s15, 0
    s_cbranch_scc1 L_w105
    s_waitcnt vmcnt(6)
    s_cbranch_vccnz L_w105
    s_waitcnt vmcnt(4)
L_w105:
    s_waitcnt vmcnt(7)
    buffer_load_dwordx4 v6, s[48:51], s10 offen offset:1024 nt lds
    s_cmp_lg_u32 s15, 0
    s_cbranch_scc1 L_w106
    s_waitcnt vmcnt(6)
    s_cbranch_vccnz L_w106
    s_waitcnt vmcnt(4)
L_w106:
    s_waitcnt vmcnt(7)
    buffer_load_dwordx4 v6, s[48:51], s10 offen offset:2048 nt lds
    s_cmp_lg_u32 s15, 0
    s_cbranch_scc1 L_w107
    s_waitcnt vmcnt(6)
    s_cbranch_vccnz L_w107
    s_waitcnt vmcnt(4)
L_w107:
    s_waitcnt vmcnt(7)
    buffer_load_dwordx4 v6, s[48:51], s10 offen offset:3072 nt lds
    s_memrealtime s[42:43]
    ds_read_b64_tr_b16 v[112:113], v12 offset:24576
    ds_read_b64_tr_b16 v[114:115], v13 offset:24576
    ds_read_b64_tr_b16 v[116:117], v12 offset:25600
    ds_read_b64_tr_b16 v[118:119], v13 offset:25600
    ds_read_b64_tr_b16 v[120:121], v12 offset:26624
    ds_read_b64_tr_b16 v[122:123], v13 offset:26624
    ds_read_b64_tr_b16 v[124:125], v12 offset:27648
    ds_read_b64_tr_b16 v[126:127], v13 offset:27648
    s_waitcnt lgkmcnt(0)
    s_sub_u32 s42, s42, s13
    s_cmp_gt_i32 s42, 1665
    s_cselect_b64 vcc, -1, 0
    s_cmp_gt_i32 s42, 1690
    s_cselect_b32 s15, 1, 0
    v_mfma_f32_4x4x4_16b_bf16 v[152:155], v[148:149], v[112:113], v[152:155] cbsz:4 abid:0
    v_mfma_f32_4x4x4_16b_bf16 v[156:159], v[148:149], v[114:115], v[156:159] cbsz:4 abid:0
    s_nop 0
    v_mfma_f32_4x4x4_16b_bf16 v[152:155], v[148:149], v[116:117], v[152:155] cbsz:4 abid:4
    v_mfma_f32_4x4x4_16b_bf16 v[156:159], v[148:149], v[118:119], v[156:159] cbsz:4 abid:4
    s_nop 0
    v_mfma_f32_4x4x4_16b_bf16 v[152:155], v[148:149], v[120:121], v[152:155] cbsz:4 abid:8
    v_mfma_f32_4x4x4_16b_bf16 v[156:159], v[148:149], v[122:123], v[156:159] cbsz:4 abid:8
    s_nop 0
    v_mfma_f32_4x4x4_16b_bf16 v[152:155], v[148:149], v[124:125], v[152:155] cbsz:4 abid:12
    v_mfma_f32_4x4x4_16b_bf16 v[156:159], v[148:149], v[126:127], v[156:159] cbsz:4 abid:12
    s_xor_b32 s10, s7, 180224
    s_add_u32 m0, s9, 0
    s_cmp_lg_u32 s15, 0
    s_cbranch_scc1 L_w108
    s_waitcnt vmcnt(6)
    s_cbranch_vccnz L_w108
    s_waitcnt vmcnt(4)
L_w108:
    s_waitcnt vmcnt(7)
    buffer_load_dwordx4 v6, s[48:51], s10 offen offset:0 nt lds
    s_cmp_lg_u32 s15, 0
    s_cbranch_scc1 L_w109
    s_waitcnt vmcnt(6)
    s_cbranch_vccnz L_w109
    s_waitcnt vmcnt(4)
L_w109:
    s_waitcnt vmcnt(7)
    buffer_load_dwordx4 v6, s[48:51], s10 offen offset:1024 nt lds
    s_cmp_lg_u32 s15, 0
    s_cbranch_scc1 L_w110
    s_waitcnt vmcnt(6)
    s_cbranch_vccnz L_w110
    s_waitcnt vmcnt(4)
L_w110:
    s_waitcnt vmcnt(7)
    buffer_load_dwordx4 v6, s[48:51], s10 offen offset:2048 nt lds
    s_cmp_lg_u32 s15, 0
    s_cbranch_scc1 L_w111
    s_waitcnt vmcnt(6)
    s_cbranch_vccnz L_w111
    s_waitcnt vmcnt(4)
L_w111:
    s_waitcnt vmcnt(7)
    buffer_load_dwordx4 v6, s[48:51], s10 offen offset:3072 nt lds
    s_memrealtime s[42:43]
    ds_read_b64_tr_b16 v[128:129], v12 offset:28672
    ds_read_b64_tr_b16 v[130:131], v13 offset:28672
    ds_read_b64_tr_b16 v[132:133], v12 offset:29696
    ds_read_b64_tr_b16 v[134:135], v13 offset:29696
    ds_read_b64_tr_b16 v[136:137], v12 offset:30720
    ds_read_b64_tr_b16 v[138:139], v13 offset:30720
    ds_read_b64_tr_b16 v[140:141], v12 offset:31744
    ds_read_b64_tr_b16 v[142:143], v13 offset:31744
    s_waitcnt lgkmcnt(0)
    s_sub_u32 s42, s42, s13
    s_cmp_gt_i32 s42, 1721
    s_cselect_b64 vcc, -1, 0
    s_cmp_gt_i32 s42, 1746
    s_cselect_b32 s15, 1, 0
    v_mfma_f32_4x4x4_16b_bf16 v[152:155], v[148:149], v[128:129], v[152:155] cbsz:4 abid:1
    v_mfma_f32_4x4x4_16b_bf16 v[156:159], v[148:149], v[130:131], v[156:159] cbsz:4 abid:1
    s_nop 0
    v_mfma_f32_4x4x4_16b_bf16 v[152:155], v[148:149], v[132:133], v[152:155] cbsz:4 abid:5
    v_mfma_f32_4x4x4_16b_bf16 v[156:159], v[148:149], v[134:135], v[156:159] cbsz:4 abid:5
    s_nop 0
    v_mfma_f32_4x4x4_16b_bf16 v[152:155], v[148:149], v[136:137], v[152:155] cbsz:4 abid:9
    v_mfma_f32_4x4x4_16b_bf16 v[156:159], v[148:149], v[138:139], v[156:159] cbsz:4 abid:9
    s_nop 0
    v_mfma_f32_4x4x4_16b_bf16 v[152:155], v[148:149], v[140:141], v[152:155] cbsz:4 abid:13
    v_mfma_f32_4x4x4_16b_bf16 v[156:159], v[148:149], v[142:143], v[156:159] cbsz:4 abid:13
    s_xor_b32 s10, s7, 196608
    s_add_u32 m0, s9, 4096
    s_cmp_lg_u32 s15, 0
    s_cbranch_scc1 L_w112
    s_waitcnt vmcnt(6)
    s_cbranch_vccnz L_w112
    s_waitcnt vmcnt(4)
L_w112:
    s_waitcnt vmcnt(7)
    buffer_load_dwordx4 v6, s[48:51], s10 offen offset:0 nt lds
    s_cmp_lg_u32 s15, 0
    s_cbranch_scc1 L_w113
    s_waitcnt vmcnt(6)
    s_cbranch_vccnz L_w113
    s_waitcnt vmcnt(4)
L_w113:
    s_waitcnt vmcnt(7)
    buffer_load_dwordx4 v6, s[48:51], s10 offen offset:1024 nt lds
    s_cmp_lg_u32 s15, 0
    s_cbranch_scc1 L_w114
    s_waitcnt vmcnt(6)
    s_cbranch_vccnz L_w114
    s_waitcnt vmcnt(4)
L_w114:
    s_waitcnt vmcnt(7)
    buffer_load_dwordx4 v6, s[48:51], s10 offen offset:2048 nt lds
    s_cmp_lg_u32 s15, 0
    s_cbranch_scc1 L_w115
    s_waitcnt vmcnt(6)
    s_cbranch_vccnz L_w115
    s_waitcnt vmcnt(4)
L_w115:
    s_waitcnt vmcnt(7)
    buffer_load_dwordx4 v6, s[48:51], s10 offen offset:3072 nt lds
    s_memrealtime s[42:43]
    ds_read_b64_tr_b16 v[112:113], v12 offset:32768
    ds_read_b64_tr_b16 v[114:115], v13 offset:32768
    ds_read_b64_tr_b16 v[116:117], v12 offset:33792
    ds_read_b64_tr_b16 v[118:119], v13 offset:33792
    ds_read_b64_tr_b16 v[120:121], v12 offset:34816
    ds_read_b64_tr_b16 v[122:123], v13 offset:34816
    ds_read_b64_tr_b16 v[124:125], v12 offset:35840
    ds_read_b64_tr_b16 v[126:127], v13 offset:35840
    s_waitcnt lgkmcnt(0)
    s_sub_u32 s42, s42, s13
    s_cmp_gt_i32 s42, 1776
    s_cselect_b64 vcc, -1, 0
    s_cmp_gt_i32 s42, 1801
    s_cselect_b32 s15, 1, 0
    v_mfma_f32_4x4x4_16b_bf16 v[152:155], v[148:149], v[112:113], v[152:155] cbsz:4 abid:2
    v_mfma_f32_4x4x4_16b_bf16 v[156:159], v[148:149], v[114:115], v[156:159] cbsz:4 abid:2
    s_nop 0
    v_mfma_f32_4x4x4_16b_bf16 v[152:155], v[148:149], v[116:117], v[152:155] cbsz:4 abid:6
    v_mfma_f32_4x4x4_16b_bf16 v[156:159], v[148:149], v[118:119], v[156:159] cbsz:4 abid:6
    s_nop 0
    v_mfma_f32_4x4x4_16b_bf16 v[152:155], v[148:149], v[120:121], v[152:155] cbsz:4 abid:10
    v_mfma_f32_4x4x4_16b_bf16 v[156:159], v[148:149], v[122:123], v[156:159] cbsz:4 abid:10
    s_nop 0
    v_mfma_f32_4x4x4_16b_bf16 v[152:155], v[148:149], v[124:125], v[152:155] cbsz:4 abid:14
    v_mfma_f32_4x4x4_16b_bf16 v[156:159], v[148:149], v[126:127], v[156:159] cbsz:4 abid:14
    s_xor_b32 s10, s7, 212992
    s_add_u32 m0, s9, 8192
    s_cmp_lg_u32 s15, 0
    s_cbranch_scc1 L_w116
    s_waitcnt vmcnt(6)
    s_cbranch_vccnz L_w116
    s_waitcnt vmcnt(4)
L_w116:
    s_waitcnt vmcnt(7)
    buffer_load_dwordx4 v6, s[48:51], s10 offen offset:0 nt lds
    s_cmp_lg_u32 s15, 0
    s_cbranch_scc1 L_w117
    s_waitcnt vmcnt(6)
    s_cbranch_vccnz L_w117
    s_waitcnt vmcnt(4)
L_w117:
    s_waitcnt vmcnt(7)
    buffer_load_dwordx4 v6, s[48:51], s10 offen offset:1024 nt lds
    s_cmp_lg_u32 s15, 0
    s_cbranch_scc1 L_w118
    s_waitcnt vmcnt(6)
    s_cbranch_vccnz L_w118
    s_waitcnt vmcnt(4)
L_w118:
    s_waitcnt vmcnt(7)
    buffer_load_dwordx4 v6, s[48:51], s10 offen offset:2048 nt lds
    s_cmp_lg_u32 s15, 0
    s_cbranch_scc1 L_w119
    s_waitcnt vmcnt(6)
    s_cbranch_vccnz L_w119
    s_waitcnt vmcnt(4)
L_w119:
    s_waitcnt vmcnt(7)
    buffer_load_dwordx4 v6, s[48:51], s10 offen offset:3072 nt lds
    s_memrealtime s[42:43]
    ds_read_b64_tr_b16 v[128:129], v12 offset:0
    ds_read_b64_tr_b16 v[130:131], v13 offset:0
    ds_read_b64_tr_b16 v[132:133], v12 offset:1024
    ds_read_b64_tr_b16 v[134:135], v13 offset:1024
    ds_read_b64_tr_b16 v[136:137], v12 offset:2048
    ds_read_b64_tr_b16 v[138:139], v13 offset:2048
    ds_read_b64_tr_b16 v[140:141], v12 offset:3072
    ds_read_b64_tr_b16 v[142:143], v13 offset:3072
    s_waitcnt lgkmcnt(0)
    s_sub_u32 s42, s42, s13
    s_cmp_gt_i32 s42, 1832
    s_cselect_b64 vcc, -1, 0
    s_cmp_gt_i32 s42, 1857
    s_cselect_b32 s15, 1, 0
    v_mfma_f32_4x4x4_16b_bf16 v[152:155], v[148:149], v[128:129], v[152:155] cbsz:4 abid:3
    v_mfma_f32_4x4x4_16b_bf16 v[156:159], v[148:149], v[130:131], v[156:159] cbsz:4 abid:3
    s_nop 0
    v_mfma_f32_4x4x4_16b_bf16 v[152:155], v[148:149], v[132:133], v[152:155] cbsz:4 abid:7
    v_mfma_f32_4x4x4_16b_bf16 v[156:159], v[148:149], v[134:135], v[156:159] cbsz:4 abid:7
    s_nop 0
    v_mfma_f32_4x4x4_16b_bf16 v[152:155], v[148:149], v[136:137], v[152:155] cbsz:4 abid:11
    v_mfma_f32_4x4x4_16b_bf16 v[156:159], v[148:149], v[138:139], v[156:159] cbsz:4 abid:11
    s_nop 0
    v_mfma_f32_4x4x4_16b_bf16 v[152:155], v[148:149], v[140:141], v[152:155] cbsz:4 abid:15
    v_mfma_f32_4x4x4_16b_bf16 v[156:159], v[148:149], v[142:143], v[156:159] cbsz:4 abid:15
    s_xor_b32 s10, s7, 229376
    s_add_u32 m0, s9, 12288
    s_cmp_lg_u32 s15, 0
    s_cbranch_scc1 L_w120
    s_waitcnt vmcnt(6)
    s_cbranch_vccnz L_w120
    s_waitcnt vmcnt(4)
L_w120:
    s_waitcnt vmcnt(7)
    buffer_load_dwordx4 v6, s[48:51], s10 offen offset:0 nt lds
    s_cmp_lg_u32 s15, 0
    s_cbranch_scc1 L_w121
    s_waitcnt vmcnt(6)
    s_cbranch_vccnz L_w121
    s_waitcnt vmcnt(4)
L_w121:
    s_waitcnt vmcnt(7)
    buffer_load_dwordx4 v6, s[48:51], s10 offen offset:1024 nt lds
    s_cmp_lg_u32 s15, 0
    s_cbranch_scc1 L_w122
    s_waitcnt vmcnt(6)
    s_cbranch_vccnz L_w122
    s_waitcnt vmcnt(4)
L_w122:
    s_waitcnt vmcnt(7)
    buffer_load_dwordx4 v6, s[48:51], s10 offen offset:2048 nt lds
    s_cmp_lg_u32 s15, 0
    s_cbranch_scc1 L_w123
    s_waitcnt vmcnt(6)
    s_cbranch_vccnz L_w123
    s_waitcnt vmcnt(4)
L_w123:
    s_waitcnt vmcnt(7)
    buffer_load_dwordx4 v6, s[48:51], s10 offen offset:3072 nt lds
    s_memrealtime s[42:43]
    ds_read_b64_tr_b16 v[112:113], v12 offset:4096
    ds_read_b64_tr_b16 v[114:115], v13 offset:4096
    ds_read_b64_tr_b16 v[116:117], v12 offset:5120
    ds_read_b64_tr_b16 v[118:119], v13 offset:5120
    ds_read_b64_tr_b16 v[120:121], v12 offset:6144
    ds_read_b64_tr_b16 v[122:123], v13 offset:6144
    ds_read_b64_tr_b16 v[124:125], v12 offset:7168
    ds_read_b64_tr_b16 v[126:127], v13 offset:7168
    s_waitcnt lgkmcnt(0)
    s_sub_u32 s42, s42, s13
    s_cmp_gt_i32 s42, 1888
    s_cselect_b64 vcc, -1, 0
    s_cmp_gt_i32 s42, 1913
    s_cselect_b32 s15, 1, 0
    v_mfma_f32_4x4x4_16b_bf16 v[152:155], v[150:151], v[112:113], v[152:155] cbsz:4 abid:0
    v_mfma_f32_4x4x4_16b_bf16 v[156:159], v[150:151], v[114:115], v[156:159] cbsz:4 abid:0
    s_nop 0
    v_mfma_f32_4x4x4_16b_bf16 v[152:155], v[150:151], v[116:117], v[152:155] cbsz:4 abid:4
    v_mfma_f32_4x4x4_16b_bf16 v[156:159], v[150:151], v[118:119], v[156:159] cbsz:4 abid:4
    s_nop 0
    v_mfma_f32_4x4x4_16b_bf16 v[152:155], v[150:151], v[120:121], v[152:155] cbsz:4 abid:8
    v_mfma_f32_4x4x4_16b_bf16 v[156:159], v[150:151], v[122:123], v[156:159] cbsz:4 abid:8
    s_nop 0
    v_mfma_f32_4x4x4_16b_bf16 v[152:155], v[150:151], v[124:125], v[152:155] cbsz:4 abid:12
    v_mfma_f32_4x4x4_16b_bf16 v[156:159], v[150:151], v[126:127], v[156:159] cbsz:4 abid:12
    s_xor_b32 s10, s7, 245760
    s_add_u32 m0, s9, 16384
    s_cmp_lg_u32 s15, 0
    s_cbranch_scc1 L_w124
    s_waitcnt vmcnt(6)
    s_cbranch_vccnz L_w124
    s_waitcnt vmcnt(4)
L_w124:
    s_waitcnt vmcnt(7)
    buffer_load_dwordx4 v6, s[48:51], s10 offen offset:0 nt lds
    s_cmp_lg_u32 s15, 0
    s_cbranch_scc1 L_w125
    s_waitcnt vmcnt(6)
    s_cbranch_vccnz L_w125
    s_waitcnt vmcnt(4)
L_w125:
    s_waitcnt vmcnt(7)
    buffer_load_dwordx4 v6, s[48:51], s10 offen offset:1024 nt lds
    s_cmp_lg_u32 s15, 0
    s_cbranch_scc1 L_w126
    s_waitcnt vmcnt(6)
    s_cbranch_vccnz L_w126
    s_waitcnt vmcnt(4)
L_w126:
    s_waitcnt vmcnt(7)
    buffer_load_dwordx4 v6, s[48:51], s10 offen offset:2048 nt lds
    s_cmp_lg_u32 s15, 0
    s_cbranch_scc1 L_w127
    s_waitcnt vmcnt(6)
    s_cbranch_vccnz L_w127
    s_waitcnt vmcnt(4)
L_w127:
    s_waitcnt vmcnt(7)
    buffer_load_dwordx4 v6, s[48:51], s10 offen offset:3072 nt lds
    ds_read_b64_tr_b16 v[128:129], v12 offset:8192
    ds_read_b64_tr_b16 v[130:131], v13 offset:8192
    ds_read_b64_tr_b16 v[132:133], v12 offset:9216
    ds_read_b64_tr_b16 v[134:135], v13 offset:9216
    ds_read_b64_tr_b16 v[136:137], v12 offset:10240
    ds_read_b64_tr_b16 v[138:139], v13 offset:10240
    ds_read_b64_tr_b16 v[140:141], v12 offset:11264
    ds_read_b64_tr_b16 v[142:143], v13 offset:11264
    s_waitcnt lgkmcnt(0)
    v_mfma_f32_4x4x4_16b_bf16 v[152:155], v[150:151], v[128:129], v[152:155] cbsz:4 abid:1
    v_mfma_f32_4x4x4_16b_bf16 v[156:159], v[150:151], v[130:131], v[156:159] cbsz:4 abid:1
    s_nop 0
    v_mfma_f32_4x4x4_16b_bf16 v[152:155], v[150:151], v[132:133], v[152:155] cbsz:4 abid:5
    v_mfma_f32_4x4x4_16b_bf16 v[156:159], v[150:151], v[134:135], v[156:159] cbsz:4 abid:5
    s_nop 0
    v_mfma_f32_4x4x4_16b_bf16 v[152:155], v[150:151], v[136:137], v[152:155] cbsz:4 abid:9
    v_mfma_f32_4x4x4_16b_bf16 v[156:159], v[150:151], v[138:139], v[156:159] cbsz:4 abid:9
    s_nop 0
    v_mfma_f32_4x4x4_16b_bf16 v[152:155], v[150:151], v[140:141], v[152:155] cbsz:4 abid:13
    v_mfma_f32_4x4x4_16b_bf16 v[156:159], v[150:151], v[142:143], v[156:159] cbsz:4 abid:13
    s_waitcnt vmcnt(4)
    ds_read_b64_tr_b16 v[112:113], v12 offset:12288
    ds_read_b64_tr_b16 v[114:115], v13 offset:12288
    ds_read_b64_tr_b16 v[116:117], v12 offset:13312
    ds_read_b64_tr_b16 v[118:119], v13 offset:13312
    ds_read_b64_tr_b16 v[120:121], v12 offset:14336
    ds_read_b64_tr_b16 v[122:123], v13 offset:14336
    ds_read_b64_tr_b16 v[124:125], v12 offset:15360
    ds_read_b64_tr_b16 v[126:127], v13 offset:15360
    s_waitcnt lgkmcnt(0)
    v_mfma_f32_4x4x4_16b_bf16 v[152:155], v[150:151], v[112:113], v[152:155] cbsz:4 abid:2
    v_mfma_f32_4x4x4_16b_bf16 v[156:159], v[150:151], v[114:115], v[156:159] cbsz:4 abid:2
    s_nop 0
    v_mfma_f32_4x4x4_16b_bf16 v[152:155], v[150:151], v[116:117], v[152:155] cbsz:4 abid:6
    v_mfma_f32_4x4x4_16b_bf16 v[156:159], v[150:151], v[118:119], v[156:159] cbsz:4 abid:6
    s_nop 0
    v_mfma_f32_4x4x4_16b_bf16 v[152:155], v[150:151], v[120:121], v[152:155] cbsz:4 abid:10
    v_mfma_f32_4x4x4_16b_bf16 v[156:159], v[150:151], v[122:123], v[156:159] cbsz:4 abid:10
    s_nop 0
    v_mfma_f32_4x4x4_16b_bf16 v[152:155], v[150:151], v[124:125], v[152:155] cbsz:4 abid:14
    v_mfma_f32_4x4x4_16b_bf16 v[156:159], v[150:151], v[126:127], v[156:159] cbsz:4 abid:14
    s_waitcnt vmcnt(0)
    ds_read_b64_tr_b16 v[128:129], v12 offset:16384
    ds_read_b64_tr_b16 v[130:131], v13 offset:16384
    ds_read_b64_tr_b16 v[132:133], v12 offset:17408
    ds_read_b64_tr_b16 v[134:135], v13 offset:17408
    ds_read_b64_tr_b16 v[136:137], v12 offset:18432
    ds_read_b64_tr_b16 v[138:139], v13 offset:18432
    ds_read_b64_tr_b16 v[140:141], v12 offset:19456
    ds_read_b64_tr_b16 v[142:143], v13 offset:19456
    s_waitcnt lgkmcnt(0)
    v_mfma_f32_4x4x4_16b_bf16 v[152:155], v[150:151], v[128:129], v[152:155] cbsz:4 abid:3
    v_mfma_f32_4x4x4_16b_bf16 v[156:159], v[150:151], v[130:131], v[156:159] cbsz:4 abid:3
    s_nop 0
    v_mfma_f32_4x4x4_16b_bf16 v[152:155], v[150:151], v[132:133], v[152:155] cbsz:4 abid:7
    v_mfma_f32_4x4x4_16b_bf16 v[156:159], v[150:151], v[134:135], v[156:159] cbsz:4 abid:7
    s_nop 0
    v_mfma_f32_4x4x4_16b_bf16 v[152:155], v[150:151], v[136:137], v[152:155] cbsz:4 abid:11
    v_mfma_f32_4x4x4_16b_bf16 v[156:159], v[150:151], v[138:139], v[156:159] cbsz:4 abid:11
    s_nop 0
    v_mfma_f32_4x4x4_16b_bf16 v[152:155], v[150:151], v[140:141], v[152:155] cbsz:4 abid:15
    v_mfma_f32_4x4x4_16b_bf16 v[156:159], v[150:151], v[142:143], v[156:159] cbsz:4 abid:15
    s_nop 3
    ds_write_b128 v26, v[152:155]
    ds_write_b128 v26, v[156:159] offset:1024
    s_waitcnt lgkmcnt(0)
    s_barrier
    s_endpgm
L_ctrl:
    s_setprio 3
    v_lshlrev_b32 v1, 4, v0
    v_lshrrev_b32 v3, 3, v0
    v_lshlrev_b32 v2, 17, v3
    v_and_b32 v4, 7, v0
    v_lshl_add_u32 v2, v4, 4, v2
    v_lshlrev_b32 v3, 5, v3
    s_lshr_b32 s7, s5, 3
    s_lshl_b32 s63, s4, 3
    s_and_b32 s9, s5, 7
    s_add_u32 s63, s63, s9
    s_lshl_b32 s8, s7, 20
    s_lshl_b32 s9, s63, 7
    s_add_u32 s8, s8, s9
    s_lshr_b32 s69, s63, 3
    s_lshl_b32 s69, s69, 14
    s_lshl_b32 s9, s7, 12
    s_add_u32 s69, s69, s9
    s_and_b32 s9, s63, 7
    s_lshl_b32 s9, s9, 9
    s_add_u32 s69, s69, s9
    s_add_u32 s69, s69, 851968
    s_lshl_b32 s7, s7, 8
    s_lshl_b32 s13, s4, 5
    s_add_u32 s13, s13, s5
    s_mov_b32 s46, 1028
    s_mov_b32 s47, 0x00020000
    s_mov_b32 s50, 0x400000
    s_mov_b32 s51, 0x00020000
    s_mov_b32 s54, 8388608
    s_mov_b32 s55, 0x00020000
    v_lshlrev_b32 v141, 2, v0
    v_mov_b32 v140, 0
    v_mov_b32 v139, -1
    v_add_u32 v141, 148480, v141
    ds_write_b32 v141, v140
    ds_write_b32 v141, v139 offset:256
    v_and_b32 v147, 7, v0
    v_lshlrev_b32 v147, 6, v147
    v_lshrrev_b32 v148, 4, v0
    v_lshl_add_u32 v147, v148, 4, v147
    v_add_u32 v147, 1048576, v147
    v_mov_b32 v148, 0
    v_mov_b32 v149, 0
    v_mov_b32 v150, 0
    v_mov_b32 v151, 1
    v_add_u32 v152, 1048576, v1
    s_waitcnt lgkmcnt(0)
    s_load_dword s14, s[40:41], 0
    s_mov_b32 s44, s16
    s_mov_b32 s45, s17
    s_mov_b32 s48, s22
    s_mov_b32 s49, s23
    s_mov_b32 s52, s40
    s_mov_b32 s53, s41
    s_mov_b32 exec_lo, 0x00ff00ff
    s_mov_b32 exec_hi, 0x00ff00ff
    buffer_store_dwordx4 v[148:151], v147, s[52:55], s69 offen
    s_mov_b64 exec, -1
    buffer_load_dwordx4 v[4:7], v1, s[44:47], 0 offen
    buffer_load_dwordx4 v[24:27], v3, s[44:47], s7 offen
    buffer_load_dwordx4 v[28:31], v3, s[44:47], s7 offen offset:16
    buffer_load_dwordx4 v[64:67], v2, s[48:51], s8 offen nt
    s_add_u32 s8, s8, 8192
    buffer_load_dwordx4 v[68:71], v2, s[48:51], s8 offen nt
    s_add_u32 s8, s8, 8192
    buffer_load_dwordx4 v[72:75], v2, s[48:51], s8 offen nt
    s_add_u32 s8, s8, 8192
    buffer_load_dwordx4 v[76:79], v2, s[48:51], s8 offen nt
    s_add_u32 s8, s8, 8192
    buffer_load_dwordx4 v[80:83], v2, s[48:51], s8 offen nt
    s_add_u32 s8, s8, 8192
    buffer_load_dwordx4 v[84:87], v2, s[48:51], s8 offen nt
    s_add_u32 s8, s8, 8192
    buffer_load_dwordx4 v[88:91], v2, s[48:51], s8 offen nt
    s_add_u32 s8, s8, 8192
    buffer_load_dwordx4 v[92:95], v2, s[48:51], s8 offen nt
    s_add_u32 s8, s8, 8192
    buffer_load_dwordx4 v[96:99], v2, s[48:51], s8 offen nt
    s_add_u32 s8, s8, 8192
    buffer_load_dwordx4 v[100:103], v2, s[48:51], s8 offen nt
    s_add_u32 s8, s8, 8192
    buffer_load_dwordx4 v[104:107], v2, s[48:51], s8 offen nt
    s_add_u32 s8, s8, 8192
    buffer_load_dwordx4 v[108:111], v2, s[48:51], s8 offen nt
    s_add_u32 s8, s8, 8192
    buffer_load_dwordx4 v[112:115], v2, s[48:51], s8 offen nt
    s_add_u32 s8, s8, 8192
    buffer_load_dwordx4 v[116:119], v2, s[48:51], s8 offen nt
    s_add_u32 s8, s8, 8192
    buffer_load_dwordx4 v[120:123], v2, s[48:51], s8 offen nt
    s_add_u32 s8, s8, 8192
    buffer_load_dwordx4 v[124:127], v2, s[48:51], s8 offen nt
    s_lshl_b32 s56, s13, 7
    s_add_u32 s56, s56, 32768
    s_mul_i32 s57, s13, 2048
    s_add_u32 s57, s57, 2621440
    s_and_b32 s58, s5, 1
    s_lshl_b32 s58, s58, 7
    s_lshr_b32 s9, s5, 1
    s_lshl_b32 s9, s9, 3
    s_add_u32 s58, s58, s9
    s_add_u32 s58, s58, s4
    s_lshr_b32 s9, s58, 7
    s_mul_i32 s9, s9, 65536
    s_and_b32 s58, s58, 127
    s_lshl_b32 s58, s58, 4
    s_add_u32 s58, s58, s9
    s_add_u32 s58, s58, 3211264
    s_mul_i32 s58, s13, 1024
    s_add_u32 s58, s58, 3211264
    s_barrier
    s_waitcnt vmcnt(18)
    v_lshlrev_b32 v8, 16, v4
    v_and_b32 v9, s6, v4
    v_lshlrev_b32 v10, 16, v5
    v_and_b32 v11, s6, v5
    v_lshlrev_b32 v12, 16, v6
    v_and_b32 v13, s6, v6
    v_lshlrev_b32 v14, 16, v7
    v_and_b32 v15, s6, v7
    v_add_f32 v20, v8, v9
    v_add_f32 v21, v10, v11
    v_add_f32 v22, v12, v13
    v_add_f32 v23, v14, v15
    v_add_f32 v20, v20, v21
    v_add_f32 v22, v22, v23
    v_add_f32 v20, v20, v22
    s_nop 1
    v_add_f32 v20, v20, v20 quad_perm:[1,0,3,2] row_mask:0xf bank_mask:0xf
    s_nop 1
    v_add_f32 v20, v20, v20 quad_perm:[2,3,0,1] row_mask:0xf bank_mask:0xf
    s_nop 1
    v_add_f32 v20, v20, v20 row_ror:4 row_mask:0xf bank_mask:0xf
    s_nop 1
    v_add_f32 v20, v20, v20 row_ror:8 row_mask:0xf bank_mask:0xf
    v_mov_b32 v21, v20
    s_nop 1
    v_permlane16_swap_b32 v20, v21
    v_add_f32 v20, v20, v21
    v_mov_b32 v21, v20
    s_nop 1
    v_permlane32_swap_b32 v20, v21
    v_add_f32 v20, v20, v21
    v_mul_f32 v20, 0x3b000000, v20
    v_cvt_pk_bf16_f32 v21, v20, v20
    v_lshlrev_b32 v21, 16, v21
    v_sub_f32 v8, v8, v20
    v_sub_f32 v9, v9, v20
    v_sub_f32 v10, v10, v20
    v_sub_f32 v11, v11, v20
    v_sub_f32 v12, v12, v20
    v_sub_f32 v13, v13, v20
    v_sub_f32 v14, v14, v20
    v_sub_f32 v15, v15, v20
    v_mul_f32 v22, v8, v8
    v_mul_f32 v23, v9, v9
    v_fmac_f32 v22, v10, v10
    v_fmac_f32 v23, v11, v11
    v_fmac_f32 v22, v12, v12
    v_fmac_f32 v23, v13, v13
    v_fmac_f32 v22, v14, v14
    v_fmac_f32 v23, v15, v15
    v_add_f32 v22, v22, v23
    s_nop 1
    v_add_f32 v22, v22, v22 quad_perm:[1,0,3,2] row_mask:0xf bank_mask:0xf
    s_nop 1
    v_add_f32 v22, v22, v22 quad_perm:[2,3,0,1] row_mask:0xf bank_mask:0xf
    s_nop 1
    v_add_f32 v22, v22, v22 row_ror:4 row_mask:0xf bank_mask:0xf
    s_nop 1
    v_add_f32 v22, v22, v22 row_ror:8 row_mask:0xf bank_mask:0xf
    v_mov_b32 v23, v22
    s_nop 1
    v_permlane16_swap_b32 v22, v23
    v_add_f32 v22, v22, v23
    v_mov_b32 v23, v22
    s_nop 1
    v_permlane32_swap_b32 v22, v23
    v_add_f32 v22, v22, v23
    v_mul_f32 v22, 0x3b000000, v22
    v_cvt_pk_bf16_f32 v22, v22, v22
    v_lshlrev_b32 v22, 16, v22
    v_add_f32 v22, 0x3727c5ac, v22
    v_cvt_pk_bf16_f32 v22, v22, v22
    v_lshlrev_b32 v22, 16, v22
    v_sqrt_f32 v22, v22
    s_nop 0
    v_cvt_pk_bf16_f32 v22, v22, v22
    v_lshlrev_b32 v22, 16, v22
    v_rcp_f32 v22, v22
    s_waitcnt vmcnt(16)
    v_lshlrev_b32 v48, 16, v24
    v_and_b32 v49, s6, v24
    v_lshlrev_b32 v50, 16, v25
    v_and_b32 v51, s6, v25
    v_lshlrev_b32 v52, 16, v26
    v_and_b32 v53, s6, v26
    v_lshlrev_b32 v54, 16, v27
    v_and_b32 v55, s6, v27
    v_lshlrev_b32 v56, 16, v28
    v_and_b32 v57, s6, v28
    v_lshlrev_b32 v58, 16, v29
    v_and_b32 v59, s6, v29
    v_lshlrev_b32 v60, 16, v30
    v_and_b32 v61, s6, v30
    v_lshlrev_b32 v62, 16, v31
    v_and_b32 v63, s6, v31
    v_sub_f32 v48, v48, v21
    v_sub_f32 v49, v49, v21
    v_sub_f32 v50, v50, v21
    v_sub_f32 v51, v51, v21
    v_sub_f32 v52, v52, v21
    v_sub_f32 v53, v53, v21
    v_sub_f32 v54, v54, v21
    v_sub_f32 v55, v55, v21
    v_sub_f32 v56, v56, v21
    v_sub_f32 v57, v57, v21
    v_sub_f32 v58, v58, v21
    v_sub_f32 v59, v59, v21
    v_sub_f32 v60, v60, v21
    v_sub_f32 v61, v61, v21
    v_sub_f32 v62, v62, v21
    v_sub_f32 v63, v63, v21
    v_cvt_pk_bf16_f32 v32, v48, v49
    v_cvt_pk_bf16_f32 v33, v50, v51
    v_cvt_pk_bf16_f32 v34, v52, v53
    v_cvt_pk_bf16_f32 v35, v54, v55
    v_cvt_pk_bf16_f32 v36, v56, v57
    v_cvt_pk_bf16_f32 v37, v58, v59
    v_cvt_pk_bf16_f32 v38, v60, v61
    v_cvt_pk_bf16_f32 v39, v62, v63
    v_lshlrev_b32 v48, 16, v32
    v_and_b32 v49, s6, v32
    v_lshlrev_b32 v50, 16, v33
    v_and_b32 v51, s6, v33
    v_lshlrev_b32 v52, 16, v34
    v_and_b32 v53, s6, v34
    v_lshlrev_b32 v54, 16, v35
    v_and_b32 v55, s6, v35
    v_lshlrev_b32 v56, 16, v36
    v_and_b32 v57, s6, v36
    v_lshlrev_b32 v58, 16, v37
    v_and_b32 v59, s6, v37
    v_lshlrev_b32 v60, 16, v38
    v_and_b32 v61, s6, v38
    v_lshlrev_b32 v62, 16, v39
    v_and_b32 v63, s6, v39
    v_mul_f32 v48, v48, v22
    v_mul_f32 v49, v49, v22
    v_mul_f32 v50, v50, v22
    v_mul_f32 v51, v51, v22
    v_mul_f32 v52, v52, v22
    v_mul_f32 v53, v53, v22
    v_mul_f32 v54, v54, v22
    v_mul_f32 v55, v55, v22
    v_mul_f32 v56, v56, v22
    v_mul_f32 v57, v57, v22
    v_mul_f32 v58, v58, v22
    v_mul_f32 v59, v59, v22
    v_mul_f32 v60, v60, v22
    v_mul_f32 v61, v61, v22
    v_mul_f32 v62, v62, v22
    v_mul_f32 v63, v63, v22
    v_cvt_pk_bf16_f32 v32, v48, 0
    v_cvt_pk_bf16_f32 v48, 0, v48
    v_cvt_pk_bf16_f32 v33, v49, 0
    v_cvt_pk_bf16_f32 v49, 0, v49
    v_cvt_pk_bf16_f32 v34, v50, 0
    v_cvt_pk_bf16_f32 v50, 0, v50
    v_cvt_pk_bf16_f32 v35, v51, 0
    v_cvt_pk_bf16_f32 v51, 0, v51
    v_cvt_pk_bf16_f32 v36, v52, 0
    v_cvt_pk_bf16_f32 v52, 0, v52
    v_cvt_pk_bf16_f32 v37, v53, 0
    v_cvt_pk_bf16_f32 v53, 0, v53
    v_cvt_pk_bf16_f32 v38, v54, 0
    v_cvt_pk_bf16_f32 v54, 0, v54
    v_cvt_pk_bf16_f32 v39, v55, 0
    v_cvt_pk_bf16_f32 v55, 0, v55
    v_cvt_pk_bf16_f32 v40, v56, 0
    v_cvt_pk_bf16_f32 v56, 0, v56
    v_cvt_pk_bf16_f32 v41, v57, 0
    v_cvt_pk_bf16_f32 v57, 0, v57
    v_cvt_pk_bf16_f32 v42, v58, 0
    v_cvt_pk_bf16_f32 v58, 0, v58
    v_cvt_pk_bf16_f32 v43, v59, 0
    v_cvt_pk_bf16_f32 v59, 0, v59
    v_cvt_pk_bf16_f32 v44, v60, 0
    v_cvt_pk_bf16_f32 v60, 0, v60
    v_cvt_pk_bf16_f32 v45, v61, 0
    v_cvt_pk_bf16_f32 v61, 0, v61
    v_cvt_pk_bf16_f32 v46, v62, 0
    v_cvt_pk_bf16_f32 v62, 0, v62
    v_cvt_pk_bf16_f32 v47, v63, 0
    v_cvt_pk_bf16_f32 v63, 0, v63
    v_mov_b32 v128, 0
    v_mov_b32 v129, 0
    v_mov_b32 v130, 0
    v_mov_b32 v131, 0
    v_mov_b32 v132, 0
    v_mov_b32 v133, 0
    v_mov_b32 v134, 0
    v_mov_b32 v135, 0
    v_and_b32 v2, 7, v0
    v_lshlrev_b32 v2, 6, v2
    v_lshrrev_b32 v3, 4, v0
    v_lshl_add_u32 v2, v3, 4, v2
    s_waitcnt vmcnt(12)
    v_dot2c_f32_bf16 v128, v64, v32
    v_dot2c_f32_bf16 v129, v64, v48
    v_dot2c_f32_bf16 v130, v65, v32
    v_dot2c_f32_bf16 v131, v65, v48
    v_dot2c_f32_bf16 v132, v66, v32
    v_dot2c_f32_bf16 v133, v66, v48
    v_dot2c_f32_bf16 v134, v67, v32
    v_dot2c_f32_bf16 v135, v67, v48
    v_dot2c_f32_bf16 v128, v68, v33
    v_dot2c_f32_bf16 v129, v68, v49
    v_dot2c_f32_bf16 v130, v69, v33
    v_dot2c_f32_bf16 v131, v69, v49
    v_dot2c_f32_bf16 v132, v70, v33
    v_dot2c_f32_bf16 v133, v70, v49
    v_dot2c_f32_bf16 v134, v71, v33
    v_dot2c_f32_bf16 v135, v71, v49
    v_dot2c_f32_bf16 v128, v72, v34
    v_dot2c_f32_bf16 v129, v72, v50
    v_dot2c_f32_bf16 v130, v73, v34
    v_dot2c_f32_bf16 v131, v73, v50
    v_dot2c_f32_bf16 v132, v74, v34
    v_dot2c_f32_bf16 v133, v74, v50
    v_dot2c_f32_bf16 v134, v75, v34
    v_dot2c_f32_bf16 v135, v75, v50
    v_dot2c_f32_bf16 v128, v76, v35
    v_dot2c_f32_bf16 v129, v76, v51
    v_dot2c_f32_bf16 v130, v77, v35
    v_dot2c_f32_bf16 v131, v77, v51
    v_dot2c_f32_bf16 v132, v78, v35
    v_dot2c_f32_bf16 v133, v78, v51
    v_dot2c_f32_bf16 v134, v79, v35
    v_dot2c_f32_bf16 v135, v79, v51
    s_waitcnt vmcnt(8)
    v_dot2c_f32_bf16 v128, v80, v36
    v_dot2c_f32_bf16 v129, v80, v52
    v_dot2c_f32_bf16 v130, v81, v36
    v_dot2c_f32_bf16 v131, v81, v52
    v_dot2c_f32_bf16 v132, v82, v36
    v_dot2c_f32_bf16 v133, v82, v52
    v_dot2c_f32_bf16 v134, v83, v36
    v_dot2c_f32_bf16 v135, v83, v52
    v_dot2c_f32_bf16 v128, v84, v37
    v_dot2c_f32_bf16 v129, v84, v53
    v_dot2c_f32_bf16 v130, v85, v37
    v_dot2c_f32_bf16 v131, v85, v53
    v_dot2c_f32_bf16 v132, v86, v37
    v_dot2c_f32_bf16 v133, v86, v53
    v_dot2c_f32_bf16 v134, v87, v37
    v_dot2c_f32_bf16 v135, v87, v53
    v_dot2c_f32_bf16 v128, v88, v38
    v_dot2c_f32_bf16 v129, v88, v54
    v_dot2c_f32_bf16 v130, v89, v38
    v_dot2c_f32_bf16 v131, v89, v54
    v_dot2c_f32_bf16 v132, v90, v38
    v_dot2c_f32_bf16 v133, v90, v54
    v_dot2c_f32_bf16 v134, v91, v38
    v_dot2c_f32_bf16 v135, v91, v54
    v_dot2c_f32_bf16 v128, v92, v39
    v_dot2c_f32_bf16 v129, v92, v55
    v_dot2c_f32_bf16 v130, v93, v39
    v_dot2c_f32_bf16 v131, v93, v55
    v_dot2c_f32_bf16 v132, v94, v39
    v_dot2c_f32_bf16 v133, v94, v55
    v_dot2c_f32_bf16 v134, v95, v39
    v_dot2c_f32_bf16 v135, v95, v55
    s_waitcnt vmcnt(4)
    v_dot2c_f32_bf16 v128, v96, v40
    v_dot2c_f32_bf16 v129, v96, v56
    v_dot2c_f32_bf16 v130, v97, v40
    v_dot2c_f32_bf16 v131, v97, v56
    v_dot2c_f32_bf16 v132, v98, v40
    v_dot2c_f32_bf16 v133, v98, v56
    v_dot2c_f32_bf16 v134, v99, v40
    v_dot2c_f32_bf16 v135, v99, v56
    v_dot2c_f32_bf16 v128, v100, v41
    v_dot2c_f32_bf16 v129, v100, v57
    v_dot2c_f32_bf16 v130, v101, v41
    v_dot2c_f32_bf16 v131, v101, v57
    v_dot2c_f32_bf16 v132, v102, v41
    v_dot2c_f32_bf16 v133, v102, v57
    v_dot2c_f32_bf16 v134, v103, v41
    v_dot2c_f32_bf16 v135, v103, v57
    v_dot2c_f32_bf16 v128, v104, v42
    v_dot2c_f32_bf16 v129, v104, v58
    v_dot2c_f32_bf16 v130, v105, v42
    v_dot2c_f32_bf16 v131, v105, v58
    v_dot2c_f32_bf16 v132, v106, v42
    v_dot2c_f32_bf16 v133, v106, v58
    v_dot2c_f32_bf16 v134, v107, v42
    v_dot2c_f32_bf16 v135, v107, v58
    v_dot2c_f32_bf16 v128, v108, v43
    v_dot2c_f32_bf16 v129, v108, v59
    v_dot2c_f32_bf16 v130, v109, v43
    v_dot2c_f32_bf16 v131, v109, v59
    v_dot2c_f32_bf16 v132, v110, v43
    v_dot2c_f32_bf16 v133, v110, v59
    v_dot2c_f32_bf16 v134, v111, v43
    v_dot2c_f32_bf16 v135, v111, v59
    s_waitcnt vmcnt(0)
    v_dot2c_f32_bf16 v128, v112, v44
    v_dot2c_f32_bf16 v129, v112, v60
    v_dot2c_f32_bf16 v130, v113, v44
    v_dot2c_f32_bf16 v131, v113, v60
    v_dot2c_f32_bf16 v132, v114, v44
    v_dot2c_f32_bf16 v133, v114, v60
    v_dot2c_f32_bf16 v134, v115, v44
    v_dot2c_f32_bf16 v135, v115, v60
    v_dot2c_f32_bf16 v128, v116, v45
    v_dot2c_f32_bf16 v129, v116, v61
    v_dot2c_f32_bf16 v130, v117, v45
    v_dot2c_f32_bf16 v131, v117, v61
    v_dot2c_f32_bf16 v132, v118, v45
    v_dot2c_f32_bf16 v133, v118, v61
    v_dot2c_f32_bf16 v134, v119, v45
    v_dot2c_f32_bf16 v135, v119, v61
    v_dot2c_f32_bf16 v128, v120, v46
    v_dot2c_f32_bf16 v129, v120, v62
    v_dot2c_f32_bf16 v130, v121, v46
    v_dot2c_f32_bf16 v131, v121, v62
    v_dot2c_f32_bf16 v132, v122, v46
    v_dot2c_f32_bf16 v133, v122, v62
    v_dot2c_f32_bf16 v134, v123, v46
    v_dot2c_f32_bf16 v135, v123, v62
    v_dot2c_f32_bf16 v128, v124, v47
    v_dot2c_f32_bf16 v129, v124, v63
    v_dot2c_f32_bf16 v130, v125, v47
    v_dot2c_f32_bf16 v131, v125, v63
    v_dot2c_f32_bf16 v132, v126, v47
    v_dot2c_f32_bf16 v133, v126, v63
    v_dot2c_f32_bf16 v134, v127, v47
    v_dot2c_f32_bf16 v135, v127, v63
    v_permlane32_swap_b32 v128, v132
    v_permlane32_swap_b32 v129, v133
    v_permlane32_swap_b32 v130, v134
    v_permlane32_swap_b32 v131, v135
    v_add_f32 v128, v128, v132
    v_add_f32 v129, v129, v133
    v_add_f32 v130, v130, v134
    v_add_f32 v131, v131, v135
    s_nop 0
    v_permlane16_swap_b32 v128, v130
    v_permlane16_swap_b32 v129, v131
    v_add_f32 v128, v128, v130
    v_add_f32 v129, v129, v131
    s_nop 0
    v_add_f32 v128, v128, v128 row_ror:8 row_mask:0xf bank_mask:0xf
    v_add_f32 v129, v129, v129 row_ror:8 row_mask:0xf bank_mask:0xf
    s_waitcnt lgkmcnt(0)
    s_add_u32 s14, s14, 1
    s_and_b32 s15, s14, 0xffff
    v_mov_b32 v30, s15
    s_and_b32 s15, s14, 0xff
    v_mov_b32 v31, s15
    v_mov_b32 v130, s14
    v_mov_b32 v131, s70
    s_mov_b32 s10, s14
    s_mov_b32 s11, s14
    v_mov_b32 v142, 0
    v_mov_b32 v143, 148960
    s_mov_b32 s12, 851968
    v_and_b32 v142, 7, v0
    v_lshlrev_b32 v142, 14, v142
    v_and_b32 v142, 7, v0
    v_lshlrev_b32 v142, 7, v142
    s_mov_b32 s12, 4096
    v_mov_b32 v148, v128
    v_mov_b32 v149, v129
    v_mov_b32 v150, s14
    v_mov_b32 v151, s14
    s_mov_b32 exec_lo, 0x00ff00ff
    s_mov_b32 exec_hi, 0x00ff00ff
    buffer_store_dwordx4 v[148:151], v147, s[52:55], s69 offen
    s_mov_b64 exec, -1
    s_lshl_b32 s64, s4, 14
    s_add_u32 s64, s64, 851968
    s_add_u32 s65, s64, 4096
    s_add_u32 s66, s64, 8192
    s_add_u32 s67, s64, 12288
    s_mov_b32 s59, 20000
    v_lshlrev_b32 v3, 2, v0
    v_add_u32 v3, 147456, v3
    s_sleep 6
    s_nop 0
L_qpa:
    buffer_load_dwordx4 v[64:67], v152, s[52:55], s64 offen offset:0 sc1
    buffer_load_dwordx4 v[68:71], v152, s[52:55], s64 offen offset:1024 sc1
    buffer_load_dwordx4 v[72:75], v152, s[52:55], s64 offen offset:2048 sc1
    buffer_load_dwordx4 v[76:79], v152, s[52:55], s64 offen offset:3072 sc1
    buffer_load_dwordx4 v[80:83], v152, s[52:55], s65 offen offset:0 sc1
    buffer_load_dwordx4 v[84:87], v152, s[52:55], s65 offen offset:1024 sc1
    buffer_load_dwordx4 v[88:91], v152, s[52:55], s65 offen offset:2048 sc1
    buffer_load_dwordx4 v[92:95], v152, s[52:55], s65 offen offset:3072 sc1
    buffer_load_dwordx4 v[96:99], v152, s[52:55], s66 offen offset:0 sc1
    buffer_load_dwordx4 v[100:103], v152, s[52:55], s66 offen offset:1024 sc1
    buffer_load_dwordx4 v[104:107], v152, s[52:55], s66 offen offset:2048 sc1
    buffer_load_dwordx4 v[108:111], v152, s[52:55], s66 offen offset:3072 sc1
    buffer_load_dwordx4 v[112:115], v152, s[52:55], s67 offen offset:0 sc1
    buffer_load_dwordx4 v[116:119], v152, s[52:55], s67 offen offset:1024 sc1
    buffer_load_dwordx4 v[120:123], v152, s[52:55], s67 offen offset:2048 sc1
    buffer_load_dwordx4 v[124:127], v152, s[52:55], s67 offen offset:3072 sc1
    s_sub_u32 s59, s59, 1
    s_waitcnt vmcnt(12)
    v_cmpx_eq_u64 vcc, s[10:11], v[66:67]
    v_cmpx_eq_u64 vcc, s[10:11], v[70:71]
    v_cmpx_eq_u64 vcc, s[10:11], v[74:75]
    v_cmpx_eq_u64 vcc, s[10:11], v[78:79]
    s_waitcnt vmcnt(8)
    v_cmpx_eq_u64 vcc, s[10:11], v[82:83]
    v_cmpx_eq_u64 vcc, s[10:11], v[86:87]
    v_cmpx_eq_u64 vcc, s[10:11], v[90:91]
    v_cmpx_eq_u64 vcc, s[10:11], v[94:95]
    s_waitcnt vmcnt(4)
    v_cmpx_eq_u64 vcc, s[10:11], v[98:99]
    v_cmpx_eq_u64 vcc, s[10:11], v[102:103]
    v_cmpx_eq_u64 vcc, s[10:11], v[106:107]
    v_cmpx_eq_u64 vcc, s[10:11], v[110:111]
    s_waitcnt vmcnt(0)
    v_cmpx_eq_u64 vcc, s[10:11], v[114:115]
    v_cmpx_eq_u64 vcc, s[10:11], v[118:119]
    v_cmpx_eq_u64 vcc, s[10:11], v[122:123]
    v_cmpx_eq_u64 vcc, s[10:11], v[126:127]
    s_cmp_eq_u64 exec, -1
    s_mov_b64 exec, -1
    s_nop 1
    s_cbranch_scc1 L_qdone
    s_cmp_lt_u32 s59, 19994
    s_cbranch_scc1 L_qpoll
    s_sleep 2
    s_branch L_qpa
L_qpoll:
    s_mov_b32 exec_lo, 0x00ff00ff
    s_mov_b32 exec_hi, 0x00ff00ff
    buffer_store_dwordx4 v[128:131], v2, s[52:55], s69 offen sc1
    s_mov_b64 exec, -1
    buffer_load_dwordx4 v[64:67], v1, s[52:55], s64 offen offset:0 sc1
    buffer_load_dwordx4 v[68:71], v1, s[52:55], s64 offen offset:1024 sc1
    buffer_load_dwordx4 v[72:75], v1, s[52:55], s64 offen offset:2048 sc1
    buffer_load_dwordx4 v[76:79], v1, s[52:55], s64 offen offset:3072 sc1
    buffer_load_dwordx4 v[80:83], v1, s[52:55], s65 offen offset:0 sc1
    buffer_load_dwordx4 v[84:87], v1, s[52:55], s65 offen offset:1024 sc1
    buffer_load_dwordx4 v[88:91], v1, s[52:55], s65 offen offset:2048 sc1
    buffer_load_dwordx4 v[92:95], v1, s[52:55], s65 offen offset:3072 sc1
    buffer_load_dwordx4 v[96:99], v1, s[52:55], s66 offen offset:0 sc1
    buffer_load_dwordx4 v[100:103], v1, s[52:55], s66 offen offset:1024 sc1
    buffer_load_dwordx4 v[104:107], v1, s[52:55], s66 offen offset:2048 sc1
    buffer_load_dwordx4 v[108:111], v1, s[52:55], s66 offen offset:3072 sc1
    buffer_load_dwordx4 v[112:115], v1, s[52:55], s67 offen offset:0 sc1
    buffer_load_dwordx4 v[116:119], v1, s[52:55], s67 offen offset:1024 sc1
    buffer_load_dwordx4 v[120:123], v1, s[52:55], s67 offen offset:2048 sc1
    buffer_load_dwordx4 v[124:127], v1, s[52:55], s67 offen offset:3072 sc1
    s_sub_u32 s59, s59, 1
    s_waitcnt vmcnt(12)
    v_cmpx_eq_u32 vcc, s10, v66
    v_cmpx_eq_u32 vcc, s10, v70
    v_cmpx_eq_u32 vcc, s10, v74
    v_cmpx_eq_u32 vcc, s10, v78
    s_waitcnt vmcnt(8)
    v_cmpx_eq_u32 vcc, s10, v82
    v_cmpx_eq_u32 vcc, s10, v86
    v_cmpx_eq_u32 vcc, s10, v90
    v_cmpx_eq_u32 vcc, s10, v94
    s_waitcnt vmcnt(4)
    v_cmpx_eq_u32 vcc, s10, v98
    v_cmpx_eq_u32 vcc, s10, v102
    v_cmpx_eq_u32 vcc, s10, v106
    v_cmpx_eq_u32 vcc, s10, v110
    s_waitcnt vmcnt(0)
    v_cmpx_eq_u32 vcc, s10, v114
    v_cmpx_eq_u32 vcc, s10, v118
    v_cmpx_eq_u32 vcc, s10, v122
    v_cmpx_eq_u32 vcc, s10, v126
    s_cmp_eq_u64 exec, -1
    s_mov_b64 exec, -1
    s_nop 1
    s_cbranch_scc1 L_qdone
    s_cmp_lt_i32 s59, 1
    s_cbranch_scc1 L_qdone
    s_branch L_qpa
L_qdone:
    v_add_f32 v64, v64, v80
    v_add_f32 v96, v96, v112
    v_add_f32 v65, v65, v81
    v_add_f32 v97, v97, v113
    v_add_f32 v68, v68, v84
    v_add_f32 v100, v100, v116
    v_add_f32 v69, v69, v85
    v_add_f32 v101, v101, v117
    v_add_f32 v72, v72, v88
    v_add_f32 v104, v104, v120
    v_add_f32 v73, v73, v89
    v_add_f32 v105, v105, v121
    v_add_f32 v76, v76, v92
    v_add_f32 v108, v108, v124
    v_add_f32 v77, v77, v93
    v_add_f32 v109, v109, v125
    v_add_f32 v64, v64, v96
    v_add_f32 v65, v65, v97
    v_add_f32 v68, v68, v100
    v_add_f32 v69, v69, v101
    v_add_f32 v72, v72, v104
    v_add_f32 v73, v73, v105
    v_add_f32 v76, v76, v108
    v_add_f32 v77, v77, v109
    v_cvt_pk_bf16_f32 v64, v64, v65
    v_cvt_pk_bf16_f32 v68, v68, v69
    v_cvt_pk_bf16_f32 v72, v72, v73
    v_cvt_pk_bf16_f32 v76, v76, v77
    ds_write_b32 v3, v64 offset:0
    ds_write_b32 v3, v68 offset:256
    ds_write_b32 v3, v72 offset:512
    ds_write_b32 v3, v76 offset:768
    s_and_b32 s8, s70, -2
    v_mov_b32 v146, s8
    ds_write_b32 v143, v146
    s_mov_b64 exec, 0xff
    buffer_load_dwordx2 v[144:145], v142, s[52:55], s12 offen sc1
    s_mov_b32 exec_lo, 0x00ff00ff
    s_mov_b32 exec_hi, 0x00ff00ff
    buffer_store_dwordx4 v[128:131], v2, s[52:55], s69 offen sc1
    s_mov_b64 exec, -1
    s_waitcnt lgkmcnt(0)
    s_mov_b32 s48, s24
    s_mov_b32 s49, s25
    v_lshrrev_b32 v2, 5, v0
    v_lshlrev_b32 v2, 12, v2
    v_and_b32 v3, 31, v0
    v_lshl_add_u32 v2, v3, 4, v2
    s_lshl_b32 s8, s4, 19
    s_lshr_b32 s9, s5, 1
    s_lshl_b32 s9, s9, 13
    s_add_u32 s8, s8, s9
    s_and_b32 s9, s5, 1
    s_lshl_b32 s9, s9, 9
    s_add_u32 s8, s8, s9
    buffer_load_dwordx4 v[64:67], v2, s[48:51], s8 offen offset:0 nt
    buffer_load_dwordx4 v[80:83], v2, s[48:51], s8 offen offset:1024 nt
    buffer_load_dwordx4 v[96:99], v2, s[48:51], s8 offen offset:2048 nt
    buffer_load_dwordx4 v[112:115], v2, s[48:51], s8 offen offset:3072 nt
    s_add_u32 s8, s8, 0x20000
    buffer_load_dwordx4 v[68:71], v2, s[48:51], s8 offen offset:0 nt
    buffer_load_dwordx4 v[84:87], v2, s[48:51], s8 offen offset:1024 nt
    buffer_load_dwordx4 v[100:103], v2, s[48:51], s8 offen offset:2048 nt
    buffer_load_dwordx4 v[116:119], v2, s[48:51], s8 offen offset:3072 nt
    s_add_u32 s8, s8, 0x20000
    buffer_load_dwordx4 v[72:75], v2, s[48:51], s8 offen offset:0 nt
    buffer_load_dwordx4 v[88:91], v2, s[48:51], s8 offen offset:1024 nt
    buffer_load_dwordx4 v[104:107], v2, s[48:51], s8 offen offset:2048 nt
    buffer_load_dwordx4 v[120:123], v2, s[48:51], s8 offen offset:3072 nt
    s_add_u32 s8, s8, 0x20000
    buffer_load_dwordx4 v[76:79], v2, s[48:51], s8 offen offset:0 nt
    buffer_load_dwordx4 v[92:95], v2, s[48:51], s8 offen offset:1024 nt
    buffer_load_dwordx4 v[108:111], v2, s[48:51], s8 offen offset:2048 nt
    buffer_load_dwordx4 v[124:127], v2, s[48:51], s8 offen offset:3072 nt
    s_lshr_b32 s8, s2, 5
    s_and_b32 s8, s8, 1
    s_lshl_b32 s62, s8, 8
    s_and_b32 s9, s2, 15
    s_lshl_b32 s9, s9, 4
    s_add_u32 s62, s62, s9
    s_lshr_b32 s9, s2, 4
    s_and_b32 s9, s9, 1
    s_lshl_b32 s9, s9, 2
    s_add_u32 s62, s62, s9
    s_lshl_b32 s62, s62, 1
    v_and_b32 v4, 1, v0
    v_lshrrev_b32 v5, 5, v0
    v_bfe_u32 v6, v0, 4, 1
    v_lshl_add_u32 v5, v5, 1, v6
    v_lshl_add_u32 v7, v4, 3, v5
    v_lshlrev_b32 v7, 1, v7
    v_lshl_add_u32 v8, v4, 2, v5
    v_lshlrev_b32 v8, 2, v8
    v_add_u32 v8, 148864, v8
    buffer_load_ushort v9, v7, s[44:47], s62 offen
    s_waitcnt vmcnt(18)
    v_subrev_u32 v145, s70, v145
    v_cmp_eq_u32 vcc, s10, v144
    s_nop 1
    v_cndmask_b32 v145, 0, v145, vcc
    s_nop 1
    v_add_u32 v145, v145, v145 quad_perm:[1,0,3,2] row_mask:0xf bank_mask:0xf
    s_nop 1
    v_add_u32 v145, v145, v145 quad_perm:[2,3,0,1] row_mask:0xf bank_mask:0xf
    s_nop 1
    v_add_u32 v145, v145, v145 row_half_mirror row_mask:0xf bank_mask:0xf
    v_ashrrev_i32 v145, 3, v145
    v_add_u32 v145, s70, v145
    v_and_b32 v145, -2, v145
    s_mov_b64 exec, 1
    ds_write_b32 v143, v145
    s_mov_b64 exec, -1
    s_mov_b32 s8, 0x05040100
    s_mov_b32 s9, 0x07060302
    s_waitcnt vmcnt(0)
    v_perm_b32 v128, v68, v64, s8
    v_perm_b32 v129, v76, v72, s8
    v_perm_b32 v130, v68, v64, s9
    v_perm_b32 v131, v76, v72, s9
    v_perm_b32 v132, v69, v65, s8
    v_perm_b32 v133, v77, v73, s8
    v_perm_b32 v134, v69, v65, s9
    v_perm_b32 v135, v77, v73, s9
    v_perm_b32 v136, v70, v66, s8
    v_perm_b32 v137, v78, v74, s8
    v_perm_b32 v138, v70, v66, s9
    v_perm_b32 v139, v78, v74, s9
    v_perm_b32 v140, v71, v67, s8
    v_perm_b32 v141, v79, v75, s8
    v_perm_b32 v142, v71, v67, s9
    v_perm_b32 v143, v79, v75, s9
    v_perm_b32 v144, v84, v80, s8
    v_perm_b32 v145, v92, v88, s8
    v_perm_b32 v146, v84, v80, s9
    v_perm_b32 v147, v92, v88, s9
    v_perm_b32 v148, v85, v81, s8
    v_perm_b32 v149, v93, v89, s8
    v_perm_b32 v150, v85, v81, s9
    v_perm_b32 v151, v93, v89, s9
    v_perm_b32 v152, v86, v82, s8
    v_perm_b32 v153, v94, v90, s8
    v_perm_b32 v154, v86, v82, s9
    v_perm_b32 v155, v94, v90, s9
    v_perm_b32 v156, v87, v83, s8
    v_perm_b32 v157, v95, v91, s8
    v_perm_b32 v158, v87, v83, s9
    v_perm_b32 v159, v95, v91, s9
    v_perm_b32 v160, v100, v96, s8
    v_perm_b32 v161, v108, v104, s8
    v_perm_b32 v162, v100, v96, s9
    v_perm_b32 v163, v108, v104, s9
    v_perm_b32 v164, v101, v97, s8
    v_perm_b32 v165, v109, v105, s8
    v_perm_b32 v166, v101, v97, s9
    v_perm_b32 v167, v109, v105, s9
    v_perm_b32 v168, v102, v98, s8
    v_perm_b32 v169, v110, v106, s8
    v_perm_b32 v170, v102, v98, s9
    v_perm_b32 v171, v110, v106, s9
    v_perm_b32 v172, v103, v99, s8
    v_perm_b32 v173, v111, v107, s8
    v_perm_b32 v174, v103, v99, s9
    v_perm_b32 v175, v111, v107, s9
    v_perm_b32 v176, v116, v112, s8
    v_perm_b32 v177, v124, v120, s8
    v_perm_b32 v178, v116, v112, s9
    v_perm_b32 v179, v124, v120, s9
    v_perm_b32 v180, v117, v113, s8
    v_perm_b32 v181, v125, v121, s8
    v_perm_b32 v182, v117, v113, s9
    v_perm_b32 v183, v125, v121, s9
    v_perm_b32 v184, v118, v114, s8
    v_perm_b32 v185, v126, v122, s8
    v_perm_b32 v186, v118, v114, s9
    v_perm_b32 v187, v126, v122, s9
    v_perm_b32 v188, v119, v115, s8
    v_perm_b32 v189, v127, v123, s8
    v_perm_b32 v190, v119, v115, s9
    v_perm_b32 v191, v127, v123, s9
    v_lshlrev_b32 v9, 16, v9
    v_and_b32 v10, 7, v0
    v_lshlrev_b32 v10, 4, v10
    v_add_u32 v11, 148736, v10
    s_mov_b32 s59, 160000
    s_nop 0
L_spoll:
    ds_read_b128 v[32:35], v11
    s_sub_u32 s59, s59, 1
    s_cmp_eq_u32 s59, 0
    s_cbranch_scc1 L_sdone
    s_waitcnt lgkmcnt(0)
    v_cmp_u_f32 vcc, v32, v33
    v_cmp_u_f32 s[8:9], v34, v35
    s_or_b64 vcc, vcc, s[8:9]
    s_nop 2
    s_cbranch_vccz L_sdone
    s_sleep 4
    s_branch L_spoll
L_sdone:
    s_waitcnt lgkmcnt(0)
    v_or_b32 v32, v30, v32
    v_or_b32 v34, v30, v34
    s_getreg_b32 s9, hwreg(HW_REG_XCC_ID, 0, 4)
    v_mov_b32 v18, s9
    v_and_or_b32 v33, v33, -16, v18
    v_and_or_b32 v35, v35, -16, v18
    s_mov_b64 exec, 0xff
    buffer_store_dwordx4 v[32:35], v1, s[52:55], s56 offen sc1
    s_mov_b64 exec, -1
    v_lshrrev_b32 v11, 3, v0
    v_xor_b32 v11, s5, v11
    v_lshl_add_u32 v10, v11, 7, v10
    v_xor_b32 v11, 1024, v10
    v_xor_b32 v12, 2048, v10
    v_xor_b32 v13, 3072, v10
    s_lshl_b32 s8, s4, 12
    s_add_u32 s8, s8, 32768
    s_mov_b32 s59, 20000
    s_mov_b32 s12, 0x3fb8aa3b
    s_sleep 64
L_gpoll:
    buffer_load_dwordx4 v[32:35], v10, s[52:55], s8 offen sc1
    buffer_load_dwordx4 v[36:39], v11, s[52:55], s8 offen sc1
    buffer_load_dwordx4 v[40:43], v12, s[52:55], s8 offen sc1
    buffer_load_dwordx4 v[44:47], v13, s[52:55], s8 offen sc1
    s_sub_u32 s59, s59, 1
    s_waitcnt vmcnt(0)
    v_xor_b32 v32, v30, v32
    v_xor_b32 v34, v30, v34
    v_xor_b32 v36, v30, v36
    v_xor_b32 v38, v30, v38
    v_xor_b32 v40, v30, v40
    v_xor_b32 v42, v30, v42
    v_xor_b32 v44, v30, v44
    v_xor_b32 v46, v30, v46
    v_or3_b32 v48, v32, v34, v36
    v_or3_b32 v49, v38, v40, v42
    v_or3_b32 v48, v48, v44, v46
    v_or_b32 v48, v48, v49
    v_lshlrev_b32 v48, 16, v48
    v_cmp_ne_u32 vcc, 0, v48
    s_cmp_eq_u32 s59, 0
    s_nop 2
    s_cbranch_scc1 L_gdone
    s_cbranch_vccz L_gdone
    s_sleep 16
    s_branch L_gpoll
L_gdone:
    v_xor_b32 v33, v18, v33
    v_xor_b32 v35, v18, v35
    v_xor_b32 v37, v18, v37
    v_xor_b32 v39, v18, v39
    v_xor_b32 v41, v18, v41
    v_xor_b32 v43, v18, v43
    v_xor_b32 v45, v18, v45
    v_xor_b32 v47, v18, v47
    v_or3_b32 v48, v33, v35, v37
    v_or3_b32 v49, v39, v41, v43
    v_or3_b32 v48, v48, v45, v47
    v_or_b32 v48, v48, v49
    v_and_b32 v48, 15, v48
    v_cmp_ne_u32 s[28:29], 0, v48
    v_and_b32 v33, -16, v33
    v_and_b32 v35, -16, v35
    v_and_b32 v37, -16, v37
    v_and_b32 v39, -16, v39
    v_and_b32 v41, -16, v41
    v_and_b32 v43, -16, v43
    v_and_b32 v45, -16, v45
    v_and_b32 v47, -16, v47
    v_max3_f32 v48, v32, v36, v40
    v_max_f32 v48, v48, v44
    v_max3_f32 v49, v34, v38, v42
    v_max_f32 v49, v49, v46
    v_max_f32 v48, v48, v48 quad_perm:[2,3,0,1] row_mask:0xf bank_mask:0xf
    s_nop 0
    v_max_f32 v49, v49, v49 quad_perm:[2,3,0,1] row_mask:0xf bank_mask:0xf
    v_max_f32 v48, v48, v48 row_ror:4 row_mask:0xf bank_mask:0xf
    s_nop 0
    v_max_f32 v49, v49, v49 row_ror:4 row_mask:0xf bank_mask:0xf
    v_max_f32 v48, v48, v48 row_ror:8 row_mask:0xf bank_mask:0xf
    s_nop 0
    v_max_f32 v49, v49, v49 row_ror:8 row_mask:0xf bank_mask:0xf
    v_mov_b32 v52, v48
    v_mov_b32 v53, v49
    s_nop 0
    v_permlane16_swap_b32 v48, v52
    v_permlane16_swap_b32 v49, v53
    v_max_f32 v48, v48, v52
    v_max_f32 v49, v49, v53
    v_mov_b32 v52, v48
    v_mov_b32 v53, v49
    s_nop 0
    v_permlane32_swap_b32 v48, v52
    v_permlane32_swap_b32 v49, v53
    v_max_f32 v48, v48, v52
    v_max_f32 v49, v49, v53
    v_sub_f32 v32, v32, v48
    v_mul_f32 v32, s12, v32
    v_exp_f32 v32, v32
    v_sub_f32 v34, v34, v49
    v_mul_f32 v34, s12, v34
    v_exp_f32 v34, v34
    v_sub_f32 v36, v36, v48
    v_mul_f32 v36, s12, v36
    v_exp_f32 v36, v36
    v_sub_f32 v38, v38, v49
    v_mul_f32 v38, s12, v38
    v_exp_f32 v38, v38
    v_sub_f32 v40, v40, v48
    v_mul_f32 v40, s12, v40
    v_exp_f32 v40, v40
    v_sub_f32 v42, v42, v49
    v_mul_f32 v42, s12, v42
    v_exp_f32 v42, v42
    v_sub_f32 v44, v44, v48
    v_mul_f32 v44, s12, v44
    v_exp_f32 v44, v44
    v_sub_f32 v46, v46, v49
    v_mul_f32 v46, s12, v46
    v_exp_f32 v46, v46
    v_mul_f32 v50, v32, v33
    v_fmac_f32 v50, v36, v37
    v_fmac_f32 v50, v40, v41
    v_fmac_f32 v50, v44, v45
    v_mul_f32 v51, v34, v35
    v_fmac_f32 v51, v38, v39
    v_fmac_f32 v51, v42, v43
    v_fmac_f32 v51, v46, v47
    v_add_f32 v50, v50, v50 quad_perm:[2,3,0,1] row_mask:0xf bank_mask:0xf
    s_nop 0
    v_add_f32 v51, v51, v51 quad_perm:[2,3,0,1] row_mask:0xf bank_mask:0xf
    v_add_f32 v50, v50, v50 row_ror:4 row_mask:0xf bank_mask:0xf
    s_nop 0
    v_add_f32 v51, v51, v51 row_ror:4 row_mask:0xf bank_mask:0xf
    v_add_f32 v50, v50, v50 row_ror:8 row_mask:0xf bank_mask:0xf
    s_nop 0
    v_add_f32 v51, v51, v51 row_ror:8 row_mask:0xf bank_mask:0xf
    v_mov_b32 v52, v50
    v_mov_b32 v53, v51
    s_nop 0
    v_permlane16_swap_b32 v50, v52
    v_permlane16_swap_b32 v51, v53
    v_add_f32 v50, v50, v52
    v_add_f32 v51, v51, v53
    v_mov_b32 v52, v50
    v_mov_b32 v53, v51
    s_nop 0
    v_permlane32_swap_b32 v50, v52
    v_permlane32_swap_b32 v51, v53
    v_add_f32 v50, v50, v52
    v_add_f32 v51, v51, v53
    v_rcp_f32 v50, v50
    v_rcp_f32 v51, v51
    v_mul_f32 v48, v32, v50
    v_mul_f32 v49, v34, v51
    v_readlane_b32 s86, v48, 0
    v_readlane_b32 s87, v49, 0
    v_readlane_b32 s88, v48, 1
    v_readlane_b32 s89, v49, 1
    v_readlane_b32 s90, v48, 2
    v_readlane_b32 s91, v49, 2
    v_readlane_b32 s92, v48, 3
    v_readlane_b32 s93, v49, 3
    v_readlane_b32 s94, v48, 4
    v_readlane_b32 s95, v49, 4
    v_readlane_b32 s96, v48, 5
    v_readlane_b32 s97, v49, 5
    v_readlane_b32 s98, v48, 6
    v_readlane_b32 s99, v49, 6
    v_readlane_b32 s100, v48, 7
    v_readlane_b32 s101, v49, 7
    s_getpc_b64 s[60:61]
L_pc_t:
    v_lshlrev_b32 v228, 7, v0
    v_min_u32 v224, L_code_end-L_pc_t-132, v228
    v_and_b32 v224, -4, v224
    v_mov_b32 v225, s61
    v_add_co_u32 v224, vcc, s60, v224
    s_nop 1
    v_addc_co_u32 v225, vcc, 0, v225, vcc
    global_load_dword v226, v[224:225], off
    v_bfe_u32 v10, v0, 2, 3
    v_mul_u32_u24 v10, 2048, v10
    v_lshrrev_b32 v11, 5, v0
    v_lshl_add_u32 v10, v11, 6, v10
    v_and_b32 v11, 3, v0
    v_lshl_add_u32 v10, v11, 4, v10
    s_mul_i32 s8, s4, 65536
    s_lshr_b32 s9, s5, 1
    s_lshl_b32 s9, s9, 7
    s_add_u32 s8, s8, s9
    s_add_u32 s64, s8, 2621440
    s_add_u32 s65, s64, 16384
    s_add_u32 s66, s64, 32768
    s_add_u32 s67, s64, 49152
    v_lshrrev_b32 v17, 1, v0
    v_mul_u32_u24 v17, 2048, v17
    v_lshl_add_u32 v17, v4, 4, v17
    v_lshrrev_b32 v11, 1, v0
    v_lshlrev_b32 v11, 4, v11
    v_lshl_add_u32 v11, v4, 4, v11
    s_and_b32 s8, s2, 63
    s_mul_i32 s8, s8, 2048
    s_add_u32 s24, s8, 3211264
    s_add_u32 s25, s24, 512
    s_add_u32 s26, s24, 1024
    s_add_u32 s27, s24, 1536
    v_and_b32 v11, 15, v0
    v_mul_u32_u24 v11, 2048, v11
    v_lshrrev_b32 v17, 4, v0
    v_lshl_add_u32 v11, v17, 4, v11
    s_lshl_b32 s8, s4, 5
    s_and_b32 s9, s5, 1
    s_add_u32 s8, s8, s9
    s_mul_i32 s8, s8, 1024
    s_lshr_b32 s9, s5, 1
    s_lshl_b32 s9, s9, 6
    s_add_u32 s8, s8, s9
    s_add_u32 s24, s8, 3211264
    v_mul_u32_u24 v19, 512, v17
    v_mov_b32 v16, 148928
    buffer_load_dwordx4 v[96:99], v11, s[52:55], s24 offen sc1
    s_and_b32 s8, s5, 1
    s_lshl_b32 s8, s8, 5
    s_and_b32 s9, s5, 30
    s_add_u32 s8, s8, s9
    s_lshl_b32 s8, s8, 1
    s_mul_i32 s8, s8, 512
    s_lshl_b32 s9, s4, 4
    s_add_u32 s8, s8, s9
    s_add_u32 s25, s8, 3670016
    v_add_u32 v12, 73728, v1
    s_mov_b32 s15, 0xffffff00
    s_mov_b32 s48, s36
    s_mov_b32 s49, s37
    s_mov_b32 s50, 1028
    s_mov_b32 s59, 20000
    s_waitcnt vmcnt(0)
    s_barrier
    ds_read_b128 v[192:195], v1 offset:0
    ds_read_b128 v[196:199], v1 offset:36864
    ds_read_b128 v[200:203], v12 offset:0
    ds_read_b128 v[204:207], v12 offset:36864
    ds_read_b128 v[208:211], v1 offset:1024
    ds_read_b128 v[212:215], v1 offset:37888
    ds_read_b128 v[216:219], v12 offset:1024
    ds_read_b128 v[220:223], v12 offset:37888
    ds_read_b32 v13, v8
    s_waitcnt lgkmcnt(8)
    v_mul_f32 v192, s86, v192
    v_mul_f32 v193, s87, v193
    v_mul_f32 v194, s88, v194
    v_mul_f32 v195, s89, v195
    s_waitcnt lgkmcnt(7)
    v_fmac_f32 v192, s90, v196
    v_fmac_f32 v193, s91, v197
    v_fmac_f32 v194, s92, v198
    v_fmac_f32 v195, s93, v199
    s_waitcnt lgkmcnt(6)
    v_fmac_f32 v192, s94, v200
    v_fmac_f32 v193, s95, v201
    v_fmac_f32 v194, s96, v202
    v_fmac_f32 v195, s97, v203
    s_waitcnt lgkmcnt(5)
    v_fmac_f32 v192, s98, v204
    v_fmac_f32 v193, s99, v205
    v_fmac_f32 v194, s100, v206
    v_fmac_f32 v195, s101, v207
    v_and_or_b32 v192, v192, s15, v31
    s_cmp_eq_u64 s[28:29], 0
    s_cbranch_scc1 L_pl0
    buffer_store_dwordx4 v[192:195], v1, s[52:55], s57 offen offset:0 sc1
    s_branch L_pd0
L_pl0:
    buffer_store_dwordx4 v[192:195], v1, s[52:55], s57 offen offset:0
L_pd0:
    s_waitcnt lgkmcnt(4)
    v_mul_f32 v208, s86, v208
    v_mul_f32 v209, s87, v209
    v_mul_f32 v210, s88, v210
    v_mul_f32 v211, s89, v211
    s_waitcnt lgkmcnt(3)
    v_fmac_f32 v208, s90, v212
    v_fmac_f32 v209, s91, v213
    v_fmac_f32 v210, s92, v214
    v_fmac_f32 v211, s93, v215
    s_waitcnt lgkmcnt(2)
    v_fmac_f32 v208, s94, v216
    v_fmac_f32 v209, s95, v217
    v_fmac_f32 v210, s96, v218
    v_fmac_f32 v211, s97, v219
    s_waitcnt lgkmcnt(1)
    v_fmac_f32 v208, s98, v220
    v_fmac_f32 v209, s99, v221
    v_fmac_f32 v210, s100, v222
    v_fmac_f32 v211, s101, v223
    v_and_or_b32 v208, v208, s15, v31
    s_cmp_eq_u64 s[28:29], 0
    s_cbranch_scc1 L_pl1
    buffer_store_dwordx4 v[208:211], v1, s[52:55], s57 offen offset:1024 sc1
    s_branch L_pd1
L_pl1:
    buffer_store_dwordx4 v[208:211], v1, s[52:55], s57 offen offset:1024
L_pd1:
    buffer_load_dwordx4 v[32:35], v10, s[52:55], s64 offen sc1
    buffer_load_dwordx4 v[36:39], v10, s[52:55], s65 offen sc1
    buffer_load_dwordx4 v[40:43], v10, s[52:55], s66 offen sc1
    buffer_load_dwordx4 v[44:47], v10, s[52:55], s67 offen sc1
    s_sleep 1
L_h1poll:
    buffer_load_dwordx4 v[224:227], v10, s[52:55], s64 offen sc1
    buffer_load_dwordx4 v[228:231], v10, s[52:55], s65 offen sc1
    buffer_load_dwordx4 v[232:235], v10, s[52:55], s66 offen sc1
    buffer_load_dwordx4 v[236:239], v10, s[52:55], s67 offen sc1
    s_sub_u32 s59, s59, 1
    s_waitcnt vmcnt(6)
    v_xor_b32 v32, v31, v32
    v_xor_b32 v36, v31, v36
    v_or_b32 v60, v32, v36
    v_add_f32 v32, v32, v36
    v_add_f32 v33, v33, v37
    v_add_f32 v34, v34, v38
    v_add_f32 v35, v35, v39
    s_waitcnt vmcnt(4)
    v_xor_b32 v40, v31, v40
    v_xor_b32 v44, v31, v44
    v_or3_b32 v60, v60, v40, v44
    v_add_f32 v41, v41, v45
    v_lshlrev_b32 v60, 24, v60
    v_add_f32 v42, v42, v46
    v_cmp_ne_u32 vcc, 0, v60
    v_add_f32 v43, v43, v47
    v_add_f32 v40, v40, v44
    v_add_f32 v57, v33, v41
    v_add_f32 v58, v34, v42
    v_add_f32 v59, v35, v43
    v_add_f32 v56, v32, v40
    s_cbranch_vccz L_h1done
    buffer_load_dwordx4 v[32:35], v10, s[52:55], s64 offen sc1
    buffer_load_dwordx4 v[36:39], v10, s[52:55], s65 offen sc1
    buffer_load_dwordx4 v[40:43], v10, s[52:55], s66 offen sc1
    buffer_load_dwordx4 v[44:47], v10, s[52:55], s67 offen sc1
    s_waitcnt vmcnt(6)
    v_xor_b32 v224, v31, v224
    v_xor_b32 v228, v31, v228
    v_or_b32 v60, v224, v228
    v_add_f32 v224, v224, v228
    v_add_f32 v225, v225, v229
    v_add_f32 v226, v226, v230
    v_add_f32 v227, v227, v231
    s_waitcnt vmcnt(4)
    v_xor_b32 v232, v31, v232
    v_xor_b32 v236, v31, v236
    v_or3_b32 v60, v60, v232, v236
    v_add_f32 v233, v233, v237
    v_lshlrev_b32 v60, 24, v60
    v_add_f32 v234, v234, v238
    v_cmp_ne_u32 vcc, 0, v60
    v_add_f32 v235, v235, v239
    v_add_f32 v232, v232, v236
    v_add_f32 v57, v225, v233
    v_add_f32 v58, v226, v234
    v_add_f32 v59, v227, v235
    v_add_f32 v56, v224, v232
    s_cmp_eq_u32 s59, 0
    s_cbranch_scc1 L_h1done
    s_cbranch_vccnz L_h1poll
L_h1done:
    v_permlane16_swap_b32 v56, v58
    v_permlane16_swap_b32 v57, v59
    v_add_f32 v56, v56, v58
    v_add_f32 v57, v57, v59
    s_nop 0
    v_add_f32 v56, v56, v56 row_ror:4 row_mask:0xf bank_mask:0xf
    v_add_f32 v57, v57, v57 row_ror:4 row_mask:0xf bank_mask:0xf
    s_nop 0
    v_add_f32 v56, v56, v56 row_ror:8 row_mask:0xf bank_mask:0xf
    v_add_f32 v57, v57, v57 row_ror:8 row_mask:0xf bank_mask:0xf
    v_cvt_pk_bf16_f32 v48, v56, v57
    v_mov_b32 v49, v48
    s_nop 1
    v_permlane16_swap_b32 v48, v49
    s_nop 1
    v_mov_b32 v50, v48 quad_perm:[1,1,1,1] row_mask:0xf bank_mask:0xf
    v_mov_b32 v51, v49 quad_perm:[1,1,1,1] row_mask:0xf bank_mask:0xf
    v_mov_b32 v52, v48 quad_perm:[2,2,2,2] row_mask:0xf bank_mask:0xf
    v_mov_b32 v53, v49 quad_perm:[2,2,2,2] row_mask:0xf bank_mask:0xf
    v_mov_b32 v54, v48 quad_perm:[3,3,3,3] row_mask:0xf bank_mask:0xf
    v_mov_b32 v55, v49 quad_perm:[3,3,3,3] row_mask:0xf bank_mask:0xf
    v_mfma_f32_4x4x4_16b_bf16 v[64:67], v[48:49], v[128:129], 0 cbsz:3 abid:0
    v_mfma_f32_4x4x4_16b_bf16 v[68:71], v[48:49], v[130:131], 0 cbsz:3 abid:0
    v_mfma_f32_4x4x4_16b_bf16 v[72:75], v[48:49], v[132:133], 0 cbsz:3 abid:0
    v_mfma_f32_4x4x4_16b_bf16 v[76:79], v[48:49], v[134:135], 0 cbsz:3 abid:0
    v_mfma_f32_4x4x4_16b_bf16 v[80:83], v[48:49], v[136:137], 0 cbsz:3 abid:0
    v_mfma_f32_4x4x4_16b_bf16 v[84:87], v[48:49], v[138:139], 0 cbsz:3 abid:0
    v_mfma_f32_4x4x4_16b_bf16 v[88:91], v[48:49], v[140:141], 0 cbsz:3 abid:0
    v_mfma_f32_4x4x4_16b_bf16 v[92:95], v[48:49], v[142:143], 0 cbsz:3 abid:0
    v_mfma_f32_4x4x4_16b_bf16 v[64:67], v[50:51], v[144:145], v[64:67] cbsz:3 abid:0
    v_mfma_f32_4x4x4_16b_bf16 v[68:71], v[50:51], v[146:147], v[68:71] cbsz:3 abid:0
    v_mfma_f32_4x4x4_16b_bf16 v[72:75], v[50:51], v[148:149], v[72:75] cbsz:3 abid:0
    v_mfma_f32_4x4x4_16b_bf16 v[76:79], v[50:51], v[150:151], v[76:79] cbsz:3 abid:0
    v_mfma_f32_4x4x4_16b_bf16 v[80:83], v[50:51], v[152:153], v[80:83] cbsz:3 abid:0
    v_mfma_f32_4x4x4_16b_bf16 v[84:87], v[50:51], v[154:155], v[84:87] cbsz:3 abid:0
    v_mfma_f32_4x4x4_16b_bf16 v[88:91], v[50:51], v[156:157], v[88:91] cbsz:3 abid:0
    v_mfma_f32_4x4x4_16b_bf16 v[92:95], v[50:51], v[158:159], v[92:95] cbsz:3 abid:0
    v_mfma_f32_4x4x4_16b_bf16 v[64:67], v[52:53], v[160:161], v[64:67] cbsz:3 abid:0
    v_mfma_f32_4x4x4_16b_bf16 v[68:71], v[52:53], v[162:163], v[68:71] cbsz:3 abid:0
    v_mfma_f32_4x4x4_16b_bf16 v[72:75], v[52:53], v[164:165], v[72:75] cbsz:3 abid:0
    v_mfma_f32_4x4x4_16b_bf16 v[76:79], v[52:53], v[166:167], v[76:79] cbsz:3 abid:0
    v_mfma_f32_4x4x4_16b_bf16 v[80:83], v[52:53], v[168:169], v[80:83] cbsz:3 abid:0
    v_mfma_f32_4x4x4_16b_bf16 v[84:87], v[52:53], v[170:171], v[84:87] cbsz:3 abid:0
    v_mfma_f32_4x4x4_16b_bf16 v[88:91], v[52:53], v[172:173], v[88:91] cbsz:3 abid:0
    v_mfma_f32_4x4x4_16b_bf16 v[92:95], v[52:53], v[174:175], v[92:95] cbsz:3 abid:0
    v_mfma_f32_4x4x4_16b_bf16 v[64:67], v[54:55], v[176:177], v[64:67] cbsz:3 abid:0
    v_mfma_f32_4x4x4_16b_bf16 v[68:71], v[54:55], v[178:179], v[68:71] cbsz:3 abid:0
    v_mfma_f32_4x4x4_16b_bf16 v[72:75], v[54:55], v[180:181], v[72:75] cbsz:3 abid:0
    v_mfma_f32_4x4x4_16b_bf16 v[76:79], v[54:55], v[182:183], v[76:79] cbsz:3 abid:0
    v_mfma_f32_4x4x4_16b_bf16 v[80:83], v[54:55], v[184:185], v[80:83] cbsz:3 abid:0
    v_mfma_f32_4x4x4_16b_bf16 v[84:87], v[54:55], v[186:187], v[84:87] cbsz:3 abid:0
    v_mfma_f32_4x4x4_16b_bf16 v[88:91], v[54:55], v[188:189], v[88:91] cbsz:3 abid:0
    v_mfma_f32_4x4x4_16b_bf16 v[92:95], v[54:55], v[190:191], v[92:95] cbsz:3 abid:0
    s_nop 1
    v_permlane32_swap_b32 v64, v80
    v_permlane32_swap_b32 v68, v84
    v_permlane32_swap_b32 v72, v88
    v_permlane32_swap_b32 v76, v92
    v_add_f32 v56, v64, v80
    v_add_f32 v57, v68, v84
    v_add_f32 v58, v72, v88
    v_add_f32 v59, v76, v92
    v_and_or_b32 v56, v56, s15, v31
    s_cmp_eq_u64 s[28:29], 0
    s_cbranch_scc1 L_pl2
    buffer_store_dwordx4 v[56:59], v1, s[52:55], s58 offen sc1
    s_branch L_pd2
L_pl2:
    buffer_store_dwordx4 v[56:59], v1, s[52:55], s58 offen
L_pd2:
    s_mov_b32 s59, 20000
    buffer_load_dwordx4 v[96:99], v11, s[52:55], s24 offen sc1
    s_sleep 1
    buffer_load_dwordx4 v[104:107], v11, s[52:55], s24 offen sc1
    s_sleep 1
L_2apoll:
    buffer_load_dwordx4 v[108:111], v11, s[52:55], s24 offen sc1
    s_sub_u32 s59, s59, 1
    s_waitcnt vmcnt(2)
    v_xor_b32 v96, v31, v96
    v_add_f32 v101, v97, v97 quad_perm:[1,0,3,2] row_mask:0xf bank_mask:0xf
    v_add_f32 v102, v98, v98 quad_perm:[1,0,3,2] row_mask:0xf bank_mask:0xf
    v_add_f32 v103, v99, v99 quad_perm:[1,0,3,2] row_mask:0xf bank_mask:0xf
    v_lshlrev_b32 v60, 24, v96
    v_add_f32 v100, v96, v96 quad_perm:[1,0,3,2] row_mask:0xf bank_mask:0xf
    v_cmp_ne_u32 vcc, 0, v60
    s_nop 0
    v_add_f32 v100, v100, v100 quad_perm:[2,3,0,1] row_mask:0xf bank_mask:0xf
    v_add_f32 v101, v101, v101 quad_perm:[2,3,0,1] row_mask:0xf bank_mask:0xf
    v_add_f32 v102, v102, v102 quad_perm:[2,3,0,1] row_mask:0xf bank_mask:0xf
    v_add_f32 v103, v103, v103 quad_perm:[2,3,0,1] row_mask:0xf bank_mask:0xf
    s_cbranch_vccz L_2adone
    buffer_load_dwordx4 v[96:99], v11, s[52:55], s24 offen sc1
    s_waitcnt vmcnt(2)
    v_xor_b32 v104, v31, v104
    v_add_f32 v101, v105, v105 quad_perm:[1,0,3,2] row_mask:0xf bank_mask:0xf
    v_add_f32 v102, v106, v106 quad_perm:[1,0,3,2] row_mask:0xf bank_mask:0xf
    v_add_f32 v103, v107, v107 quad_perm:[1,0,3,2] row_mask:0xf bank_mask:0xf
    v_lshlrev_b32 v60, 24, v104
    v_add_f32 v100, v104, v104 quad_perm:[1,0,3,2] row_mask:0xf bank_mask:0xf
    v_cmp_ne_u32 vcc, 0, v60
    s_nop 0
    v_add_f32 v100, v100, v100 quad_perm:[2,3,0,1] row_mask:0xf bank_mask:0xf
    v_add_f32 v101, v101, v101 quad_perm:[2,3,0,1] row_mask:0xf bank_mask:0xf
    v_add_f32 v102, v102, v102 quad_perm:[2,3,0,1] row_mask:0xf bank_mask:0xf
    v_add_f32 v103, v103, v103 quad_perm:[2,3,0,1] row_mask:0xf bank_mask:0xf
    s_cbranch_vccz L_2adone
    buffer_load_dwordx4 v[104:107], v11, s[52:55], s24 offen sc1
    s_waitcnt vmcnt(2)
    v_xor_b32 v108, v31, v108
    v_add_f32 v101, v109, v109 quad_perm:[1,0,3,2] row_mask:0xf bank_mask:0xf
    v_add_f32 v102, v110, v110 quad_perm:[1,0,3,2] row_mask:0xf bank_mask:0xf
    v_add_f32 v103, v111, v111 quad_perm:[1,0,3,2] row_mask:0xf bank_mask:0xf
    v_lshlrev_b32 v60, 24, v108
    v_add_f32 v100, v108, v108 quad_perm:[1,0,3,2] row_mask:0xf bank_mask:0xf
    v_cmp_ne_u32 vcc, 0, v60
    s_nop 0
    v_add_f32 v100, v100, v100 quad_perm:[2,3,0,1] row_mask:0xf bank_mask:0xf
    v_add_f32 v101, v101, v101 quad_perm:[2,3,0,1] row_mask:0xf bank_mask:0xf
    v_add_f32 v102, v102, v102 quad_perm:[2,3,0,1] row_mask:0xf bank_mask:0xf
    v_add_f32 v103, v103, v103 quad_perm:[2,3,0,1] row_mask:0xf bank_mask:0xf
    s_cmp_eq_u32 s59, 0
    s_cbranch_scc1 L_2adone
    s_cbranch_vccnz L_2apoll
L_2adone:
    v_add_f32 v100, v100, v100 row_ror:4 row_mask:0xf bank_mask:0xf
    v_add_f32 v101, v101, v101 row_ror:4 row_mask:0xf bank_mask:0xf
    v_add_f32 v102, v102, v102 row_ror:4 row_mask:0xf bank_mask:0xf
    v_add_f32 v103, v103, v103 row_ror:4 row_mask:0xf bank_mask:0xf
    v_add_f32 v100, v100, v100 row_ror:8 row_mask:0xf bank_mask:0xf
    v_add_f32 v101, v101, v101 row_ror:8 row_mask:0xf bank_mask:0xf
    v_add_f32 v102, v102, v102 row_ror:8 row_mask:0xf bank_mask:0xf
    v_add_f32 v103, v103, v103 row_ror:8 row_mask:0xf bank_mask:0xf
    v_and_or_b32 v100, v100, s15, v31
    v_and_or_b32 v101, v101, s15, v31
    v_and_or_b32 v102, v102, s15, v31
    v_and_or_b32 v103, v103, s15, v31
    s_mov_b32 exec_lo, 0x00010001
    s_mov_b32 exec_hi, 0x00010001
    buffer_store_dwordx4 v[100:103], v19, s[52:55], s25 offen sc1
    ds_write_b32 v16, v16
    s_waitcnt vmcnt(0)
    s_waitcnt lgkmcnt(0)
    s_endpgm
L_fin:
    s_waitcnt vmcnt(0)
    s_endpgm
L_bwave:
    s_cmp_ge_u32 s2, 128
    s_cbranch_scc1 L_end
    s_setprio 0
    s_barrier
    s_cmp_ge_u32 s2, 8
    s_cbranch_scc1 L_bt0
    s_waitcnt lgkmcnt(0)
    s_load_dword s14, s[40:41], 0
    s_mov_b32 s64, s40
    s_mov_b32 s65, s41
    s_mov_b32 s66, 8388608
    s_mov_b32 s67, 0x00020000
    s_lshl_b32 s8, s2, 7
    s_add_u32 s8, s8, 4096
    v_mov_b32 v3, 0
    v_mov_b32 v29, s70
    s_waitcnt lgkmcnt(0)
    s_add_u32 s14, s14, 1
    v_mov_b32 v28, s14
    s_mov_b64 exec, 1
    buffer_store_dwordx2 v[28:29], v3, s[64:67], s8 offen sc1
    s_mov_b64 exec, -1
    s_waitcnt vmcnt(0)
L_bt0:
    s_and_b32 s8, s2, 4
    s_lshl_b32 s8, s8, 4
    s_and_b32 s9, s2, 3
    s_lshl_b32 s9, s9, 3
    s_or_b32 s8, s8, s9
    s_bfe_u32 s9, s2, 0x30003
    s_or_b32 s8, s8, s9
    s_lshr_b32 s9, s2, 6
    s_lshl_b32 s9, s9, 5
    s_or_b32 s2, s8, s9
    v_mov_b32 v28, 148960
    s_mov_b32 s14, 160000
    s_nop 0
L_bqf:
    s_sleep 8
    ds_read_b32 v29, v28
    s_sub_u32 s14, s14, 1
    s_cbranch_scc1 L_bqfd
    s_waitcnt lgkmcnt(0)
    v_readfirstlane_b32 s13, v29
    s_cmp_eq_u32 s13, -1
    s_nop 2
    s_cbranch_scc1 L_bqf
L_bqfd:
    s_waitcnt lgkmcnt(0)
    s_load_dword s14, s[40:41], 0
    s_mov_b32 s44, s16
    s_mov_b32 s45, s17
    s_mov_b32 s46, 1024
    s_mov_b32 s47, 0x00020000
    s_mov_b32 s48, s28
    s_mov_b32 s49, s29
    s_mov_b32 s50, 3584
    s_mov_b32 s51, 0x00020000
    s_mov_b32 s52, s30
    s_mov_b32 s53, s31
    s_mov_b32 s54, 3584
    s_mov_b32 s55, 0x00020000
    s_mov_b32 s56, s32
    s_mov_b32 s57, s33
    s_mov_b32 s58, 3584
    s_mov_b32 s59, 0x00020000
    s_mov_b32 s60, s34
    s_mov_b32 s61, s35
    s_mov_b32 s62, 4
    s_mov_b32 s63, 0x00020000
    v_lshlrev_b32 v1, 4, v0
    v_lshlrev_b32 v2, 3, v0
    v_mov_b32 v3, 0
    buffer_load_dwordx4 v[4:7], v1, s[44:47], 0 offen
    buffer_load_ushort v31, v3, s[60:63], 0 offen
    buffer_load_dwordx2 v[112:113], v2, s[48:51], 0 offen offset:0
    buffer_load_dwordx2 v[126:127], v2, s[52:55], 0 offen offset:0
    buffer_load_dwordx2 v[96:97], v2, s[56:59], 0 offen offset:0
    buffer_load_dwordx2 v[114:115], v2, s[48:51], 0 offen offset:512
    buffer_load_dwordx2 v[128:129], v2, s[52:55], 0 offen offset:512
    buffer_load_dwordx2 v[98:99], v2, s[56:59], 0 offen offset:512
    buffer_load_dwordx2 v[116:117], v2, s[48:51], 0 offen offset:1024
    buffer_load_dwordx2 v[130:131], v2, s[52:55], 0 offen offset:1024
    buffer_load_dwordx2 v[100:101], v2, s[56:59], 0 offen offset:1024
    buffer_load_dwordx2 v[118:119], v2, s[48:51], 0 offen offset:1536
    buffer_load_dwordx2 v[132:133], v2, s[52:55], 0 offen offset:1536
    buffer_load_dwordx2 v[102:103], v2, s[56:59], 0 offen offset:1536
    buffer_load_dwordx2 v[120:121], v2, s[48:51], 0 offen offset:2048
    buffer_load_dwordx2 v[134:135], v2, s[52:55], 0 offen offset:2048
    buffer_load_dwordx2 v[104:105], v2, s[56:59], 0 offen offset:2048
    buffer_load_dwordx2 v[122:123], v2, s[48:51], 0 offen offset:2560
    buffer_load_dwordx2 v[136:137], v2, s[52:55], 0 offen offset:2560
    buffer_load_dwordx2 v[106:107], v2, s[56:59], 0 offen offset:2560
    buffer_load_dwordx2 v[124:125], v2, s[48:51], 0 offen offset:3072
    buffer_load_dwordx2 v[138:139], v2, s[52:55], 0 offen offset:3072
    buffer_load_dwordx2 v[108:109], v2, s[56:59], 0 offen offset:3072
    s_waitcnt vmcnt(22)
    v_lshlrev_b32 v8, 16, v4
    v_and_b32 v9, s6, v4
    v_lshlrev_b32 v10, 16, v5
    v_and_b32 v11, s6, v5
    v_lshlrev_b32 v12, 16, v6
    v_and_b32 v13, s6, v6
    v_lshlrev_b32 v14, 16, v7
    v_and_b32 v15, s6, v7
    v_add_f32 v20, v8, v9
    v_add_f32 v21, v10, v11
    v_add_f32 v22, v12, v13
    v_add_f32 v23, v14, v15
    v_add_f32 v20, v20, v21
    v_add_f32 v22, v22, v23
    v_add_f32 v20, v20, v22
    s_nop 1
    v_add_f32 v20, v20, v20 quad_perm:[1,0,3,2] row_mask:0xf bank_mask:0xf
    s_nop 1
    v_add_f32 v20, v20, v20 quad_perm:[2,3,0,1] row_mask:0xf bank_mask:0xf
    s_nop 1
    v_add_f32 v20, v20, v20 row_ror:4 row_mask:0xf bank_mask:0xf
    s_nop 1
    v_add_f32 v20, v20, v20 row_ror:8 row_mask:0xf bank_mask:0xf
    v_mov_b32 v21, v20
    s_nop 1
    v_permlane16_swap_b32 v20, v21
    v_add_f32 v20, v20, v21
    v_mov_b32 v21, v20
    s_nop 1
    v_permlane32_swap_b32 v20, v21
    v_add_f32 v20, v20, v21
    v_mul_f32 v20, 0x3b000000, v20
    v_cvt_pk_bf16_f32 v21, v20, v20
    v_lshlrev_b32 v21, 16, v21
    v_sub_f32 v16, v8, v20
    v_mul_f32 v22, v16, v16
    v_sub_f32 v16, v9, v20
    v_mul_f32 v23, v16, v16
    v_sub_f32 v16, v10, v20
    v_fmac_f32 v22, v16, v16
    v_sub_f32 v16, v11, v20
    v_fmac_f32 v23, v16, v16
    v_sub_f32 v16, v12, v20
    v_fmac_f32 v22, v16, v16
    v_sub_f32 v16, v13, v20
    v_fmac_f32 v23, v16, v16
    v_sub_f32 v16, v14, v20
    v_fmac_f32 v22, v16, v16
    v_sub_f32 v16, v15, v20
    v_fmac_f32 v23, v16, v16
    v_add_f32 v22, v22, v23
    v_sub_f32 v8, v8, v21
    v_sub_f32 v9, v9, v21
    v_sub_f32 v10, v10, v21
    v_sub_f32 v11, v11, v21
    v_sub_f32 v12, v12, v21
    v_sub_f32 v13, v13, v21
    v_sub_f32 v14, v14, v21
    v_sub_f32 v15, v15, v21
    v_add_f32 v22, v22, v22 quad_perm:[1,0,3,2] row_mask:0xf bank_mask:0xf
    s_nop 1
    v_add_f32 v22, v22, v22 quad_perm:[2,3,0,1] row_mask:0xf bank_mask:0xf
    s_nop 1
    v_add_f32 v22, v22, v22 row_ror:4 row_mask:0xf bank_mask:0xf
    s_nop 1
    v_add_f32 v22, v22, v22 row_ror:8 row_mask:0xf bank_mask:0xf
    v_mov_b32 v23, v22
    s_nop 1
    v_permlane16_swap_b32 v22, v23
    v_add_f32 v22, v22, v23
    v_mov_b32 v23, v22
    s_nop 1
    v_permlane32_swap_b32 v22, v23
    v_add_f32 v22, v22, v23
    v_mul_f32 v22, 0x3b000000, v22
    v_cvt_pk_bf16_f32 v22, v22, v22
    v_lshlrev_b32 v22, 16, v22
    v_add_f32 v22, 0x3727c5ac, v22
    v_cvt_pk_bf16_f32 v22, v22, v22
    v_lshlrev_b32 v22, 16, v22
    v_sqrt_f32 v22, v22
    v_cvt_pk_bf16_f32 v16, v8, v9
    v_cvt_pk_bf16_f32 v17, v10, v11
    v_cvt_pk_bf16_f32 v18, v12, v13
    v_cvt_pk_bf16_f32 v19, v14, v15
    v_cvt_pk_bf16_f32 v22, v22, v22
    v_lshlrev_b32 v22, 16, v22
    v_rcp_f32 v22, v22
    v_lshlrev_b32 v8, 16, v16
    v_and_b32 v9, s6, v16
    v_lshlrev_b32 v10, 16, v17
    v_and_b32 v11, s6, v17
    v_lshlrev_b32 v12, 16, v18
    v_and_b32 v13, s6, v18
    v_lshlrev_b32 v14, 16, v19
    v_and_b32 v15, s6, v19
    v_mul_f32 v8, v8, v22
    v_mul_f32 v9, v9, v22
    v_mul_f32 v10, v10, v22
    v_mul_f32 v11, v11, v22
    v_mul_f32 v12, v12, v22
    v_mul_f32 v13, v13, v22
    v_mul_f32 v14, v14, v22
    v_mul_f32 v15, v15, v22
    v_cvt_pk_bf16_f32 v16, v8, v9
    v_cvt_pk_bf16_f32 v17, v10, v11
    v_cvt_pk_bf16_f32 v18, v12, v13
    v_cvt_pk_bf16_f32 v19, v14, v15
    v_lshlrev_b32 v8, 16, v16
    v_and_b32 v9, s6, v16
    v_lshlrev_b32 v10, 16, v17
    v_and_b32 v11, s6, v17
    v_lshlrev_b32 v12, 16, v18
    v_and_b32 v13, s6, v18
    v_lshlrev_b32 v14, 16, v19
    v_and_b32 v15, s6, v19
    v_add_f32 v20, v8, v9
    v_add_f32 v21, v10, v11
    v_add_f32 v22, v12, v13
    v_add_f32 v23, v14, v15
    v_add_f32 v20, v20, v21
    v_add_f32 v22, v22, v23
    v_add_f32 v20, v20, v22
    s_nop 1
    v_add_f32 v20, v20, v20 quad_perm:[1,0,3,2] row_mask:0xf bank_mask:0xf
    s_nop 1
    v_add_f32 v20, v20, v20 quad_perm:[2,3,0,1] row_mask:0xf bank_mask:0xf
    s_nop 1
    v_add_f32 v20, v20, v20 row_ror:4 row_mask:0xf bank_mask:0xf
    s_nop 1
    v_add_f32 v20, v20, v20 row_ror:8 row_mask:0xf bank_mask:0xf
    v_mov_b32 v21, v20
    s_nop 1
    v_permlane16_swap_b32 v20, v21
    v_add_f32 v20, v20, v21
    v_mov_b32 v21, v20
    s_nop 1
    v_permlane32_swap_b32 v20, v21
    v_add_f32 v20, v20, v21
    v_mul_f32 v20, 0x3b000000, v20
    v_cvt_pk_bf16_f32 v21, v20, v20
    v_lshlrev_b32 v21, 16, v21
    v_sub_f32 v4, v8, v20
    v_mul_f32 v22, v4, v4
    v_sub_f32 v4, v9, v20
    v_mul_f32 v23, v4, v4
    v_sub_f32 v4, v10, v20
    v_fmac_f32 v22, v4, v4
    v_sub_f32 v4, v11, v20
    v_fmac_f32 v23, v4, v4
    v_sub_f32 v4, v12, v20
    v_fmac_f32 v22, v4, v4
    v_sub_f32 v4, v13, v20
    v_fmac_f32 v23, v4, v4
    v_sub_f32 v4, v14, v20
    v_fmac_f32 v22, v4, v4
    v_sub_f32 v4, v15, v20
    v_fmac_f32 v23, v4, v4
    v_add_f32 v22, v22, v23
    v_sub_f32 v8, v8, v21
    v_sub_f32 v9, v9, v21
    v_sub_f32 v10, v10, v21
    v_sub_f32 v11, v11, v21
    v_sub_f32 v12, v12, v21
    v_sub_f32 v13, v13, v21
    v_sub_f32 v14, v14, v21
    v_sub_f32 v15, v15, v21
    v_add_f32 v22, v22, v22 quad_perm:[1,0,3,2] row_mask:0xf bank_mask:0xf
    s_nop 1
    v_add_f32 v22, v22, v22 quad_perm:[2,3,0,1] row_mask:0xf bank_mask:0xf
    s_nop 1
    v_add_f32 v22, v22, v22 row_ror:4 row_mask:0xf bank_mask:0xf
    s_nop 1
    v_add_f32 v22, v22, v22 row_ror:8 row_mask:0xf bank_mask:0xf
    v_mov_b32 v23, v22
    s_nop 1
    v_permlane16_swap_b32 v22, v23
    v_add_f32 v22, v22, v23
    v_mov_b32 v23, v22
    s_nop 1
    v_permlane32_swap_b32 v22, v23
    v_add_f32 v22, v22, v23
    v_mul_f32 v22, 0x3b000000, v22
    v_cvt_pk_bf16_f32 v22, v22, v22
    v_lshlrev_b32 v22, 16, v22
    v_add_f32 v22, 0x3727c5ac, v22
    v_cvt_pk_bf16_f32 v22, v22, v22
    v_lshlrev_b32 v22, 16, v22
    v_sqrt_f32 v22, v22
    v_cvt_pk_bf16_f32 v4, v8, v9
    v_cvt_pk_bf16_f32 v5, v10, v11
    v_cvt_pk_bf16_f32 v6, v12, v13
    v_cvt_pk_bf16_f32 v7, v14, v15
    v_cvt_pk_bf16_f32 v22, v22, v22
    v_lshlrev_b32 v22, 16, v22
    v_rcp_f32 v22, v22
    v_lshlrev_b32 v8, 16, v4
    v_and_b32 v9, s6, v4
    v_lshlrev_b32 v10, 16, v5
    v_and_b32 v11, s6, v5
    v_lshlrev_b32 v12, 16, v6
    v_and_b32 v13, s6, v6
    v_lshlrev_b32 v14, 16, v7
    v_and_b32 v15, s6, v7
    v_mul_f32 v8, v8, v22
    v_mul_f32 v9, v9, v22
    v_mul_f32 v10, v10, v22
    v_mul_f32 v11, v11, v22
    v_mul_f32 v12, v12, v22
    v_mul_f32 v13, v13, v22
    v_mul_f32 v14, v14, v22
    v_mul_f32 v15, v15, v22
    v_cvt_pk_bf16_f32 v4, v8, v9
    v_cvt_pk_bf16_f32 v5, v10, v11
    v_cvt_pk_bf16_f32 v6, v12, v13
    v_cvt_pk_bf16_f32 v7, v14, v15
    v_lshlrev_b32 v8, 16, v4
    v_and_b32 v9, s6, v4
    v_lshlrev_b32 v10, 16, v5
    v_and_b32 v11, s6, v5
    v_lshlrev_b32 v12, 16, v6
    v_and_b32 v13, s6, v6
    v_lshlrev_b32 v14, 16, v7
    v_and_b32 v15, s6, v7
    s_mov_b32 s7, 0
    s_lshr_b32 s8, s2, 6
    s_lshl_b32 s8, s8, 5
    s_and_b32 s9, s2, 31
    s_add_u32 s8, s8, s9
    v_readlane_b32 s64, v8, s8
    v_readlane_b32 s65, v9, s8
    v_readlane_b32 s66, v10, s8
    v_readlane_b32 s67, v11, s8
    v_readlane_b32 s68, v12, s8
    v_readlane_b32 s69, v13, s8
    v_readlane_b32 s70, v14, s8
    v_readlane_b32 s71, v15, s8
    s_bitcmp1_b32 s2, 5
    s_cselect_b32 s64, s68, s64
    s_cselect_b32 s65, s69, s65
    s_cselect_b32 s66, s70, s66
    s_cselect_b32 s67, s71, s67
    s_waitcnt vmcnt(0)
    v_lshlrev_b32 v32, 16, v112
    v_and_b32 v33, s6, v112
    v_lshlrev_b32 v64, 16, v126
    v_and_b32 v65, s6, v126
    v_lshlrev_b32 v34, 16, v113
    v_and_b32 v35, s6, v113
    v_lshlrev_b32 v66, 16, v127
    v_and_b32 v67, s6, v127
    v_lshlrev_b32 v36, 16, v114
    v_and_b32 v37, s6, v114
    v_lshlrev_b32 v68, 16, v128
    v_and_b32 v69, s6, v128
    v_lshlrev_b32 v38, 16, v115
    v_and_b32 v39, s6, v115
    v_lshlrev_b32 v70, 16, v129
    v_and_b32 v71, s6, v129
    v_lshlrev_b32 v40, 16, v116
    v_and_b32 v41, s6, v116
    v_lshlrev_b32 v72, 16, v130
    v_and_b32 v73, s6, v130
    v_lshlrev_b32 v42, 16, v117
    v_and_b32 v43, s6, v117
    v_lshlrev_b32 v74, 16, v131
    v_and_b32 v75, s6, v131
    v_lshlrev_b32 v44, 16, v118
    v_and_b32 v45, s6, v118
    v_lshlrev_b32 v76, 16, v132
    v_and_b32 v77, s6, v132
    v_lshlrev_b32 v46, 16, v119
    v_and_b32 v47, s6, v119
    v_lshlrev_b32 v78, 16, v133
    v_and_b32 v79, s6, v133
    v_lshlrev_b32 v48, 16, v120
    v_and_b32 v49, s6, v120
    v_lshlrev_b32 v80, 16, v134
    v_and_b32 v81, s6, v134
    v_lshlrev_b32 v50, 16, v121
    v_and_b32 v51, s6, v121
    v_lshlrev_b32 v82, 16, v135
    v_and_b32 v83, s6, v135
    v_lshlrev_b32 v52, 16, v122
    v_and_b32 v53, s6, v122
    v_lshlrev_b32 v84, 16, v136
    v_and_b32 v85, s6, v136
    v_lshlrev_b32 v54, 16, v123
    v_and_b32 v55, s6, v123
    v_lshlrev_b32 v86, 16, v137
    v_and_b32 v87, s6, v137
    v_lshlrev_b32 v56, 16, v124
    v_and_b32 v57, s6, v124
    v_lshlrev_b32 v88, 16, v138
    v_and_b32 v89, s6, v138
    v_lshlrev_b32 v58, 16, v125
    v_and_b32 v59, s6, v125
    v_lshlrev_b32 v90, 16, v139
    v_and_b32 v91, s6, v139
    v_lshlrev_b32 v31, 16, v31
    s_mov_b32 s10, 0xbdd2d3e8
    v_mov_b32 v30, 0xc0135761
    s_lshl_b32 s7, s7, 4
    s_add_u32 s7, s7, 148864
    v_mov_b32 v29, s7
    s_mov_b32 s11, 4
    s_nop 0
L_bcol:
    v_mov_b32 v28, 0
    v_mul_f32 v8, s64, v32
    v_mul_f32 v9, s64, v33
    v_mul_f32 v10, s64, v34
    v_mul_f32 v11, s64, v35
    v_cvt_pk_bf16_f32 v16, v8, v9
    v_cvt_pk_bf16_f32 v17, v10, v11
    v_lshlrev_b32 v8, 16, v16
    v_and_b32 v9, s6, v16
    v_lshlrev_b32 v10, 16, v17
    v_and_b32 v11, s6, v17
    v_add_f32 v8, v8, v64
    v_add_f32 v9, v9, v65
    v_add_f32 v10, v10, v66
    v_add_f32 v11, v11, v67
    v_cvt_pk_bf16_f32 v16, v8, v9
    v_cvt_pk_bf16_f32 v17, v10, v11
    v_lshlrev_b32 v8, 16, v16
    v_and_b32 v9, s6, v16
    v_lshlrev_b32 v10, 16, v17
    v_and_b32 v11, s6, v17
    v_mul_f32 v16, v8, v8
    v_mul_f32 v17, v9, v9
    v_mul_f32 v18, v10, v10
    v_mul_f32 v19, v11, v11
    v_fma_f32 v16, v16, s10, v30
    v_fma_f32 v17, v17, s10, v30
    v_fma_f32 v18, v18, s10, v30
    v_fma_f32 v19, v19, s10, v30
    v_mul_f32 v16, v16, v8
    v_mul_f32 v17, v17, v9
    v_mul_f32 v18, v18, v10
    v_mul_f32 v19, v19, v11
    v_exp_f32 v16, v16
    v_exp_f32 v17, v17
    v_exp_f32 v18, v18
    v_exp_f32 v19, v19
    v_add_f32 v16, 1.0, v16
    v_add_f32 v17, 1.0, v17
    v_add_f32 v18, 1.0, v18
    v_add_f32 v19, 1.0, v19
    v_rcp_f32 v16, v16
    v_rcp_f32 v17, v17
    v_rcp_f32 v18, v18
    v_rcp_f32 v19, v19
    v_mul_f32 v8, v8, v16
    v_mul_f32 v9, v9, v17
    v_mul_f32 v10, v10, v18
    v_mul_f32 v11, v11, v19
    v_cvt_pk_bf16_f32 v16, v8, v9
    v_cvt_pk_bf16_f32 v17, v10, v11
    v_dot2c_f32_bf16 v28, v16, v96
    v_dot2c_f32_bf16 v28, v17, v97
    v_mul_f32 v8, s64, v36
    v_mul_f32 v9, s64, v37
    v_mul_f32 v10, s64, v38
    v_mul_f32 v11, s64, v39
    v_cvt_pk_bf16_f32 v16, v8, v9
    v_cvt_pk_bf16_f32 v17, v10, v11
    v_lshlrev_b32 v8, 16, v16
    v_and_b32 v9, s6, v16
    v_lshlrev_b32 v10, 16, v17
    v_and_b32 v11, s6, v17
    v_add_f32 v8, v8, v68
    v_add_f32 v9, v9, v69
    v_add_f32 v10, v10, v70
    v_add_f32 v11, v11, v71
    v_cvt_pk_bf16_f32 v16, v8, v9
    v_cvt_pk_bf16_f32 v17, v10, v11
    v_lshlrev_b32 v8, 16, v16
    v_and_b32 v9, s6, v16
    v_lshlrev_b32 v10, 16, v17
    v_and_b32 v11, s6, v17
    v_mul_f32 v16, v8, v8
    v_mul_f32 v17, v9, v9
    v_mul_f32 v18, v10, v10
    v_mul_f32 v19, v11, v11
    v_fma_f32 v16, v16, s10, v30
    v_fma_f32 v17, v17, s10, v30
    v_fma_f32 v18, v18, s10, v30
    v_fma_f32 v19, v19, s10, v30
    v_mul_f32 v16, v16, v8
    v_mul_f32 v17, v17, v9
    v_mul_f32 v18, v18, v10
    v_mul_f32 v19, v19, v11
    v_exp_f32 v16, v16
    v_exp_f32 v17, v17
    v_exp_f32 v18, v18
    v_exp_f32 v19, v19
    v_add_f32 v16, 1.0, v16
    v_add_f32 v17, 1.0, v17
    v_add_f32 v18, 1.0, v18
    v_add_f32 v19, 1.0, v19
    v_rcp_f32 v16, v16
    v_rcp_f32 v17, v17
    v_rcp_f32 v18, v18
    v_rcp_f32 v19, v19
    v_mul_f32 v8, v8, v16
    v_mul_f32 v9, v9, v17
    v_mul_f32 v10, v10, v18
    v_mul_f32 v11, v11, v19
    v_cvt_pk_bf16_f32 v16, v8, v9
    v_cvt_pk_bf16_f32 v17, v10, v11
    v_dot2c_f32_bf16 v28, v16, v98
    v_dot2c_f32_bf16 v28, v17, v99
    v_mul_f32 v8, s64, v40
    v_mul_f32 v9, s64, v41
    v_mul_f32 v10, s64, v42
    v_mul_f32 v11, s64, v43
    v_cvt_pk_bf16_f32 v16, v8, v9
    v_cvt_pk_bf16_f32 v17, v10, v11
    v_lshlrev_b32 v8, 16, v16
    v_and_b32 v9, s6, v16
    v_lshlrev_b32 v10, 16, v17
    v_and_b32 v11, s6, v17
    v_add_f32 v8, v8, v72
    v_add_f32 v9, v9, v73
    v_add_f32 v10, v10, v74
    v_add_f32 v11, v11, v75
    v_cvt_pk_bf16_f32 v16, v8, v9
    v_cvt_pk_bf16_f32 v17, v10, v11
    v_lshlrev_b32 v8, 16, v16
    v_and_b32 v9, s6, v16
    v_lshlrev_b32 v10, 16, v17
    v_and_b32 v11, s6, v17
    v_mul_f32 v16, v8, v8
    v_mul_f32 v17, v9, v9
    v_mul_f32 v18, v10, v10
    v_mul_f32 v19, v11, v11
    v_fma_f32 v16, v16, s10, v30
    v_fma_f32 v17, v17, s10, v30
    v_fma_f32 v18, v18, s10, v30
    v_fma_f32 v19, v19, s10, v30
    v_mul_f32 v16, v16, v8
    v_mul_f32 v17, v17, v9
    v_mul_f32 v18, v18, v10
    v_mul_f32 v19, v19, v11
    v_exp_f32 v16, v16
    v_exp_f32 v17, v17
    v_exp_f32 v18, v18
    v_exp_f32 v19, v19
    v_add_f32 v16, 1.0, v16
    v_add_f32 v17, 1.0, v17
    v_add_f32 v18, 1.0, v18
    v_add_f32 v19, 1.0, v19
    v_rcp_f32 v16, v16
    v_rcp_f32 v17, v17
    v_rcp_f32 v18, v18
    v_rcp_f32 v19, v19
    v_mul_f32 v8, v8, v16
    v_mul_f32 v9, v9, v17
    v_mul_f32 v10, v10, v18
    v_mul_f32 v11, v11, v19
    v_cvt_pk_bf16_f32 v16, v8, v9
    v_cvt_pk_bf16_f32 v17, v10, v11
    v_dot2c_f32_bf16 v28, v16, v100
    v_dot2c_f32_bf16 v28, v17, v101
    v_mul_f32 v8, s64, v44
    v_mul_f32 v9, s64, v45
    v_mul_f32 v10, s64, v46
    v_mul_f32 v11, s64, v47
    v_cvt_pk_bf16_f32 v16, v8, v9
    v_cvt_pk_bf16_f32 v17, v10, v11
    v_lshlrev_b32 v8, 16, v16
    v_and_b32 v9, s6, v16
    v_lshlrev_b32 v10, 16, v17
    v_and_b32 v11, s6, v17
    v_add_f32 v8, v8, v76
    v_add_f32 v9, v9, v77
    v_add_f32 v10, v10, v78
    v_add_f32 v11, v11, v79
    v_cvt_pk_bf16_f32 v16, v8, v9
    v_cvt_pk_bf16_f32 v17, v10, v11
    v_lshlrev_b32 v8, 16, v16
    v_and_b32 v9, s6, v16
    v_lshlrev_b32 v10, 16, v17
    v_and_b32 v11, s6, v17
    v_mul_f32 v16, v8, v8
    v_mul_f32 v17, v9, v9
    v_mul_f32 v18, v10, v10
    v_mul_f32 v19, v11, v11
    v_fma_f32 v16, v16, s10, v30
    v_fma_f32 v17, v17, s10, v30
    v_fma_f32 v18, v18, s10, v30
    v_fma_f32 v19, v19, s10, v30
    v_mul_f32 v16, v16, v8
    v_mul_f32 v17, v17, v9
    v_mul_f32 v18, v18, v10
    v_mul_f32 v19, v19, v11
    v_exp_f32 v16, v16
    v_exp_f32 v17, v17
    v_exp_f32 v18, v18
    v_exp_f32 v19, v19
    v_add_f32 v16, 1.0, v16
    v_add_f32 v17, 1.0, v17
    v_add_f32 v18, 1.0, v18
    v_add_f32 v19, 1.0, v19
    v_rcp_f32 v16, v16
    v_rcp_f32 v17, v17
    v_rcp_f32 v18, v18
    v_rcp_f32 v19, v19
    v_mul_f32 v8, v8, v16
    v_mul_f32 v9, v9, v17
    v_mul_f32 v10, v10, v18
    v_mul_f32 v11, v11, v19
    v_cvt_pk_bf16_f32 v16, v8, v9
    v_cvt_pk_bf16_f32 v17, v10, v11
    v_dot2c_f32_bf16 v28, v16, v102
    v_dot2c_f32_bf16 v28, v17, v103
    v_mul_f32 v8, s64, v48
    v_mul_f32 v9, s64, v49
    v_mul_f32 v10, s64, v50
    v_mul_f32 v11, s64, v51
    v_cvt_pk_bf16_f32 v16, v8, v9
    v_cvt_pk_bf16_f32 v17, v10, v11
    v_lshlrev_b32 v8, 16, v16
    v_and_b32 v9, s6, v16
    v_lshlrev_b32 v10, 16, v17
    v_and_b32 v11, s6, v17
    v_add_f32 v8, v8, v80
    v_add_f32 v9, v9, v81
    v_add_f32 v10, v10, v82
    v_add_f32 v11, v11, v83
    v_cvt_pk_bf16_f32 v16, v8, v9
    v_cvt_pk_bf16_f32 v17, v10, v11
    v_lshlrev_b32 v8, 16, v16
    v_and_b32 v9, s6, v16
    v_lshlrev_b32 v10, 16, v17
    v_and_b32 v11, s6, v17
    v_mul_f32 v16, v8, v8
    v_mul_f32 v17, v9, v9
    v_mul_f32 v18, v10, v10
    v_mul_f32 v19, v11, v11
    v_fma_f32 v16, v16, s10, v30
    v_fma_f32 v17, v17, s10, v30
    v_fma_f32 v18, v18, s10, v30
    v_fma_f32 v19, v19, s10, v30
    v_mul_f32 v16, v16, v8
    v_mul_f32 v17, v17, v9
    v_mul_f32 v18, v18, v10
    v_mul_f32 v19, v19, v11
    v_exp_f32 v16, v16
    v_exp_f32 v17, v17
    v_exp_f32 v18, v18
    v_exp_f32 v19, v19
    v_add_f32 v16, 1.0, v16
    v_add_f32 v17, 1.0, v17
    v_add_f32 v18, 1.0, v18
    v_add_f32 v19, 1.0, v19
    v_rcp_f32 v16, v16
    v_rcp_f32 v17, v17
    v_rcp_f32 v18, v18
    v_rcp_f32 v19, v19
    v_mul_f32 v8, v8, v16
    v_mul_f32 v9, v9, v17
    v_mul_f32 v10, v10, v18
    v_mul_f32 v11, v11, v19
    v_cvt_pk_bf16_f32 v16, v8, v9
    v_cvt_pk_bf16_f32 v17, v10, v11
    v_dot2c_f32_bf16 v28, v16, v104
    v_dot2c_f32_bf16 v28, v17, v105
    v_mul_f32 v8, s64, v52
    v_mul_f32 v9, s64, v53
    v_mul_f32 v10, s64, v54
    v_mul_f32 v11, s64, v55
    v_cvt_pk_bf16_f32 v16, v8, v9
    v_cvt_pk_bf16_f32 v17, v10, v11
    v_lshlrev_b32 v8, 16, v16
    v_and_b32 v9, s6, v16
    v_lshlrev_b32 v10, 16, v17
    v_and_b32 v11, s6, v17
    v_add_f32 v8, v8, v84
    v_add_f32 v9, v9, v85
    v_add_f32 v10, v10, v86
    v_add_f32 v11, v11, v87
    v_cvt_pk_bf16_f32 v16, v8, v9
    v_cvt_pk_bf16_f32 v17, v10, v11
    v_lshlrev_b32 v8, 16, v16
    v_and_b32 v9, s6, v16
    v_lshlrev_b32 v10, 16, v17
    v_and_b32 v11, s6, v17
    v_mul_f32 v16, v8, v8
    v_mul_f32 v17, v9, v9
    v_mul_f32 v18, v10, v10
    v_mul_f32 v19, v11, v11
    v_fma_f32 v16, v16, s10, v30
    v_fma_f32 v17, v17, s10, v30
    v_fma_f32 v18, v18, s10, v30
    v_fma_f32 v19, v19, s10, v30
    v_mul_f32 v16, v16, v8
    v_mul_f32 v17, v17, v9
    v_mul_f32 v18, v18, v10
    v_mul_f32 v19, v19, v11
    v_exp_f32 v16, v16
    v_exp_f32 v17, v17
    v_exp_f32 v18, v18
    v_exp_f32 v19, v19
    v_add_f32 v16, 1.0, v16
    v_add_f32 v17, 1.0, v17
    v_add_f32 v18, 1.0, v18
    v_add_f32 v19, 1.0, v19
    v_rcp_f32 v16, v16
    v_rcp_f32 v17, v17
    v_rcp_f32 v18, v18
    v_rcp_f32 v19, v19
    v_mul_f32 v8, v8, v16
    v_mul_f32 v9, v9, v17
    v_mul_f32 v10, v10, v18
    v_mul_f32 v11, v11, v19
    v_cvt_pk_bf16_f32 v16, v8, v9
    v_cvt_pk_bf16_f32 v17, v10, v11
    v_dot2c_f32_bf16 v28, v16, v106
    v_dot2c_f32_bf16 v28, v17, v107
    v_mul_f32 v8, s64, v56
    v_mul_f32 v9, s64, v57
    v_mul_f32 v10, s64, v58
    v_mul_f32 v11, s64, v59
    v_cvt_pk_bf16_f32 v16, v8, v9
    v_cvt_pk_bf16_f32 v17, v10, v11
    v_lshlrev_b32 v8, 16, v16
    v_and_b32 v9, s6, v16
    v_lshlrev_b32 v10, 16, v17
    v_and_b32 v11, s6, v17
    v_add_f32 v8, v8, v88
    v_add_f32 v9, v9, v89
    v_add_f32 v10, v10, v90
    v_add_f32 v11, v11, v91
    v_cvt_pk_bf16_f32 v16, v8, v9
    v_cvt_pk_bf16_f32 v17, v10, v11
    v_lshlrev_b32 v8, 16, v16
    v_and_b32 v9, s6, v16
    v_lshlrev_b32 v10, 16, v17
    v_and_b32 v11, s6, v17
    v_mul_f32 v16, v8, v8
    v_mul_f32 v17, v9, v9
    v_mul_f32 v18, v10, v10
    v_mul_f32 v19, v11, v11
    v_fma_f32 v16, v16, s10, v30
    v_fma_f32 v17, v17, s10, v30
    v_fma_f32 v18, v18, s10, v30
    v_fma_f32 v19, v19, s10, v30
    v_mul_f32 v16, v16, v8
    v_mul_f32 v17, v17, v9
    v_mul_f32 v18, v18, v10
    v_mul_f32 v19, v19, v11
    v_exp_f32 v16, v16
    v_exp_f32 v17, v17
    v_exp_f32 v18, v18
    v_exp_f32 v19, v19
    v_add_f32 v16, 1.0, v16
    v_add_f32 v17, 1.0, v17
    v_add_f32 v18, 1.0, v18
    v_add_f32 v19, 1.0, v19
    v_rcp_f32 v16, v16
    v_rcp_f32 v17, v17
    v_rcp_f32 v18, v18
    v_rcp_f32 v19, v19
    v_mul_f32 v8, v8, v16
    v_mul_f32 v9, v9, v17
    v_mul_f32 v10, v10, v18
    v_mul_f32 v11, v11, v19
    v_cvt_pk_bf16_f32 v16, v8, v9
    v_cvt_pk_bf16_f32 v17, v10, v11
    v_dot2c_f32_bf16 v28, v16, v108
    v_dot2c_f32_bf16 v28, v17, v109
    s_nop 2
    v_add_f32 v28, v28, v28 quad_perm:[1,0,3,2] row_mask:0xf bank_mask:0xf
    s_nop 1
    v_add_f32 v28, v28, v28 quad_perm:[2,3,0,1] row_mask:0xf bank_mask:0xf
    s_nop 1
    v_add_f32 v28, v28, v28 row_ror:4 row_mask:0xf bank_mask:0xf
    s_nop 1
    v_add_f32 v28, v28, v28 row_ror:8 row_mask:0xf bank_mask:0xf
    v_mov_b32 v27, v28
    s_nop 1
    v_permlane16_swap_b32 v28, v27
    v_add_f32 v28, v28, v27
    v_mov_b32 v27, v28
    s_nop 1
    v_permlane32_swap_b32 v28, v27
    v_add_f32 v28, v28, v27
    v_cvt_pk_bf16_f32 v28, v28, v28
    v_lshlrev_b32 v28, 16, v28
    v_add_f32 v28, v28, v31
    v_cvt_pk_bf16_f32 v28, v28, v28
    v_lshlrev_b32 v28, 16, v28
    s_mov_b64 exec, 1
    ds_write_b32 v29, v28
    s_mov_b64 exec, -1
    v_add_u32 v29, 4, v29
    s_mov_b32 s64, s65
    s_mov_b32 s65, s66
    s_mov_b32 s66, s67
    s_sub_u32 s11, s11, 1
    s_cmp_lg_u32 s11, 0
    s_cbranch_scc1 L_bcol
    s_waitcnt lgkmcnt(0)
    s_lshl_b32 s62, s8, 3
    s_lshr_b32 s9, s2, 5
    s_and_b32 s9, s9, 1
    s_lshl_b32 s9, s9, 2
    s_add_u32 s62, s62, s9
    s_lshl_b32 s62, s62, 1
    v_bfe_u32 v5, v0, 3, 2
    v_lshlrev_b32 v7, 1, v5
    v_lshlrev_b32 v8, 2, v5
    v_add_u32 v8, 148864, v8
    buffer_load_ushort v9, v7, s[44:47], s62 offen
    s_mov_b32 s52, s40
    s_mov_b32 s53, s41
    s_mov_b32 s54, 8388608
    s_mov_b32 s55, 0x00020000
    s_mov_b32 s48, s36
    s_mov_b32 s49, s37
    s_mov_b32 s50, 1024
    s_mov_b32 s51, 0x00020000
    v_and_b32 v20, 7, v0
    v_lshlrev_b32 v20, 4, v20
    v_bfe_u32 v21, v0, 3, 2
    v_lshl_add_u32 v20, v21, 2, v20
    s_mul_i32 s26, s2, 512
    s_add_u32 s26, s26, 3670016
    s_add_u32 s14, s14, 1
    s_and_b32 s15, s14, 0xff
    v_mov_b32 v33, s15
    s_mov_b32 s59, 20000
    v_mov_b32 v2, s14
    v_mov_b32 v3, 0
    s_waitcnt vmcnt(0)
    v_lshlrev_b32 v9, 16, v9
    s_setprio 3
    s_barrier
    ds_read_b32 v13, v8
    s_waitcnt lgkmcnt(0)
    s_mov_b32 exec_hi, 0
    v_mov_b32 v16, 148928
    s_mov_b32 s58, 160000
    s_nop 0
L_gate:
    ds_read_b32 v17, v16
    s_sub_u32 s58, s58, 1
    s_cmp_eq_u32 s58, 0
    s_cbranch_scc1 L_gated
    s_waitcnt lgkmcnt(0)
    v_cmp_eq_u32 vcc, -1, v17
    s_nop 3
    s_cbranch_vccnz L_gate
L_gated:
    s_sleep 9
    buffer_load_dword v36, v20, s[52:55], s26 offen sc1
    s_sleep 1
L_fpoll:
    buffer_load_dword v37, v20, s[52:55], s26 offen sc1
    s_sub_u32 s59, s59, 1
    s_waitcnt vmcnt(1)
    v_xor_b32 v34, v33, v36
    v_lshlrev_b32 v35, 24, v34
    v_cmp_ne_u32 vcc, 0, v35
    v_add_f32 v34, v34, v34 quad_perm:[1,0,3,2] row_mask:0xf bank_mask:0xf
    s_nop 1
    v_add_f32 v34, v34, v34 quad_perm:[2,3,0,1] row_mask:0xf bank_mask:0xf
    s_nop 1
    v_add_f32 v34, v34, v34 row_half_mirror row_mask:0xf bank_mask:0xf
    v_cvt_pk_bf16_f32 v34, v34, v34
    v_lshlrev_b32 v34, 16, v34
    v_add_f32 v34, v9, v34
    v_cvt_pk_bf16_f32 v34, v34, v34
    v_lshlrev_b32 v34, 16, v34
    v_add_f32 v34, v13, v34
    v_cvt_pk_bf16_f32 v34, v34, v34
    s_cbranch_vccz L_fdone
    buffer_load_dword v36, v20, s[52:55], s26 offen sc1
    s_waitcnt vmcnt(1)
    v_xor_b32 v34, v33, v37
    v_lshlrev_b32 v35, 24, v34
    v_cmp_ne_u32 vcc, 0, v35
    v_add_f32 v34, v34, v34 quad_perm:[1,0,3,2] row_mask:0xf bank_mask:0xf
    s_nop 1
    v_add_f32 v34, v34, v34 quad_perm:[2,3,0,1] row_mask:0xf bank_mask:0xf
    s_nop 1
    v_add_f32 v34, v34, v34 row_half_mirror row_mask:0xf bank_mask:0xf
    v_cvt_pk_bf16_f32 v34, v34, v34
    v_lshlrev_b32 v34, 16, v34
    v_add_f32 v34, v9, v34
    v_cvt_pk_bf16_f32 v34, v34, v34
    v_lshlrev_b32 v34, 16, v34
    v_add_f32 v34, v13, v34
    v_cvt_pk_bf16_f32 v34, v34, v34
    s_cmp_eq_u32 s59, 0
    s_cbranch_scc1 L_fdone
    s_cbranch_vccnz L_fpoll
L_fdone:
    s_mov_b32 exec_lo, 0x01010101
    buffer_store_short v34, v7, s[48:51], s62 offen
    s_cmp_lg_u32 s2, 0
    s_cbranch_scc1 L_end
    s_mov_b64 exec, 1
    buffer_store_dword v2, v3, s[52:55], 0 offen
L_end:
    s_endpgm
.p2align 8
L_code_end:
.section .rodata,"a"
.p2align 6
.amdhsa_kernel parallel_sum__gqa_block_cached__mixer_token_mlp__decode_kernel
  .amdhsa_next_free_vgpr 256
  .amdhsa_next_free_sgpr 102
  .amdhsa_accum_offset 256
  .amdhsa_group_segment_fixed_size 0
  .amdhsa_kernarg_size 104
  .amdhsa_user_sgpr_count 2
  .amdhsa_user_sgpr_kernarg_segment_ptr 1
  .amdhsa_system_sgpr_workgroup_id_x 1
.end_amdhsa_kernel
```
